```python
import torch

def _softmax(x, axis=-1):
    return torch.softmax(x, dim=axis)

def _gelu(x):
    return torch.nn.functional.gelu(x, approximate='tanh')

def _silu(x):
    return torch.nn.functional.silu(x)

def _sigmoid(x):
    return torch.sigmoid(x)

def _layernorm(x, axis=-1, eps=1e-05):
    m = x.mean(dim=axis, keepdim=True)
    v = x.var(dim=axis, keepdim=True, unbiased=False)
    return (x - m) / torch.sqrt(v + eps)

def _scatter_add(tgt, idx, src, axis=0):
    return tgt.clone().index_add_(axis, idx, src)

def _segment_sum(src, seg, n):
    out = torch.zeros((n,) + src.shape[1:], dtype=src.dtype)
    return out.index_add_(0, seg, src)

def _pad(x, pw):
    flat = tuple((v for pair in reversed(pw) for v in pair))
    return torch.nn.functional.pad(x, flat)
kernel_name = 'gated_mix__sliding_block__mixer_gmlp__prompt'

def setup_inputs():

    _w = lambda a: (lambda t: t.to(torch.bfloat16) if t.is_floating_point() else t)(torch.as_tensor(a))

    def _A_setup():
        B, S, D = (1, 2048, 512)
        return {'x': _w((lambda *s: torch.randn(*s, dtype=torch.bfloat16) * 0.05)(B, S, D)), 'wqkv': _w((lambda *s: torch.randn(*s, dtype=torch.bfloat16) * 1.6)(D, 3 * D)), 'wo': _w((lambda *s: torch.randn(*s, dtype=torch.bfloat16) * 0.05)(D, D))}
    _A_in = _A_setup()

    def _B_setup():
        B, S, D, F = (1, 2048, 512, 1792)
        Fh = F // 2
        return {'x': _w((lambda *s: torch.randn(*s, dtype=torch.bfloat16) * 0.05)(B, S, D)), 'w_in': _w((lambda *s: torch.randn(*s, dtype=torch.bfloat16) * 0.8)(D, 2 * Fh)), 'w_sp': _w(0.01 * (lambda *s: torch.randn(*s, dtype=torch.bfloat16) * 0.8)(S, S)), 'b_sp': _w(1.0 + 0.01 * (lambda *s: torch.randn(*s, dtype=torch.bfloat16) * 0.1)(S)), 'w_out': _w((lambda *s: torch.randn(*s, dtype=torch.bfloat16) * 0.1)(Fh, D))}
    _B_in = _B_setup()
    return {'A_x': _A_in['x'], 'A_wqkv': _A_in['wqkv'], 'A_wo': _A_in['wo'], 'B_x': _B_in['x'], 'B_w_in': _B_in['w_in'], 'B_w_sp': _B_in['w_sp'], 'B_b_sp': _B_in['b_sp'], 'B_w_out': _B_in['w_out'], 'gate_w': _w((lambda *s: torch.randn(*s, dtype=torch.bfloat16) * 0.05)(512) * 16.0)}

def reference(A_x, A_wqkv, A_wo, B_x, B_w_in, B_w_sp, B_b_sp, B_w_out, gate_w):

    def _A_ref(x, wqkv, wo):
        B, S, D = x.shape
        H = 32
        Dh = D // H
        W = 256
        qkv = (lambda x, *d: x.permute(*d))((x @ wqkv).reshape(B, S, 3, H, Dh), 2, 0, 3, 1, 4)
        q, k, v = (qkv[0], qkv[1], qkv[2])
        scores = torch.einsum('bhqd,bhkd->bhqk', q, k) * Dh ** (-0.5)
        idx = torch.arange(S)
        mask = (idx[:, None] - idx[None, :] >= 0) & (idx[:, None] - idx[None, :] < W)
        scores = torch.where(mask[None, None], scores, -1000000000.0)
        p = _softmax(scores, axis=-1)
        o = torch.einsum('bhqk,bhkd->bhqd', p, v)
        return (lambda x, *d: x.permute(*d))(o, 0, 2, 1, 3).reshape(B, S, D) @ wo

    def _B_ref(x, w_in, w_sp, b_sp, w_out):
        B, S, D = x.shape
        F = w_in.shape[-1]
        Fh = F // 2
        z = _gelu(torch.einsum('bsd,df->bsf', x, w_in))
        z1 = z[..., :Fh].clone()
        z2 = _layernorm(z[..., Fh:], axis=-1)
        g = torch.einsum('ts,bsf->btf', w_sp, z2) + b_sp[None, :, None]
        return torch.einsum('bsf,fd->bsd', z1 * g, w_out)
    x = A_x
    g = _sigmoid((x * gate_w).sum(-1, keepdims=True))
    a = _A_ref(x, A_wqkv, A_wo)
    b = _B_ref(x, B_w_in, B_w_sp, B_b_sp, B_w_out)
    return g * a + (1 - g) * b
```

```asm
; @launch kernel=gm_k1_kernel grid=(256,1,1) block=(512,1,1) lds=148480
; @launch kernel=gm_k2_kernel grid=(512,1,1) block=(256,1,1) lds=49152
.amdgcn_target "amdgcn-amd-amdhsa--gfx950"
.text
.globl gm_k1_kernel
.p2align 8
.type gm_k1_kernel,@function
gm_k1_kernel:
    s_cmp_ge_u32 s2, 256
    s_cbranch_scc1 K1_end
    s_load_dwordx4 s[4:7], s[0:1], 0
    s_load_dwordx4 s[8:11], s[0:1], 32
    s_load_dwordx4 s[12:15], s[0:1], 80
    s_load_dwordx4 s[56:59], s[0:1], 56
    s_load_dwordx2 s[60:61], s[0:1], 16
    v_lshrrev_b32 v2, 6, v0
    v_and_b32 v1, 63, v0
    v_readfirstlane_b32 s20, v2
    s_and_b32 s16, s2, 7
    s_lshr_b32 s17, s2, 3
    s_lshr_b32 s18, s16, 2
    s_lshl_b32 s18, s18, 3
    s_and_b32 s43, s16, 3
    s_mul_i32 s44, s43, 30
    s_add_u32 s44, s44, s17
    s_lshr_b32 s19, s44, 3
    s_and_b32 s44, s44, 7
    s_lshl_b32 s43, s43, 1
    s_add_u32 s43, s43, s17
    s_sub_u32 s43, s43, 30
    s_cmp_ge_u32 s17, 30
    s_cselect_b32 s44, s43, s44
    s_add_u32 s18, s18, s44
    s_cmp_ge_u32 s17, 30
    s_cbranch_scc1 K1_spare
    s_cmp_lt_u32 s20, 4
    s_cbranch_scc1 K1_compute
K1_loader:
    s_setprio 1
    s_sub_u32 s20, s20, 4
    s_lshr_b32 s21, s20, 1
    s_and_b32 s22, s20, 1
    s_lshl_b32 s43, s19, 7
    s_cmp_eq_u32 s21, 0
    s_cselect_b32 s44, 1792, 0
    s_add_u32 s43, s43, s44
    s_lshl_b32 s44, s21, 7
    s_add_u32 s44, s44, 2688
    s_mul_i32 s45, s19, 3
    s_lshr_b32 s45, s45, 1
    s_add_u32 s45, s45, s21
    s_lshl_b32 s45, s45, 7
    s_cmp_eq_u32 s19, 14
    s_cselect_b32 s43, s44, s43
    s_cselect_b32 s45, 2944, s45
    s_movk_i32 s36, 3584
    s_cselect_b32 s36, 3072, s36
    s_cselect_b32 s46, 0, 1
    v_lshrrev_b32 v2, 3, v1
    v_and_b32 v3, 7, v1
    v_lshrrev_b32 v4, 1, v2
    s_lshl_b32 s44, s18, 7
    s_lshl_b32 s47, s20, 5
    s_add_u32 s44, s44, s47
    v_add_u32 v5, s44, v2
    v_lshlrev_b32 v5, 10, v5
    v_xor_b32 v6, v3, v4
    v_xor_b32 v7, 4, v6
    v_lshl_add_u32 v6, v6, 4, v5
    v_lshl_add_u32 v7, v7, 4, v5
    v_mov_b32 v16, v6
    v_add_u32 v17, 7168, v7
    v_add_u32 v18, 14336, v6
    v_add_u32 v19, 21504, v7
    v_and_b32 v5, 3, v2
    v_lshrrev_b32 v6, 2, v2
    v_lshl_add_u32 v5, v6, 3, v5
    v_lshlrev_b32 v6, 1, v4
    v_xor_b32 v6, v3, v6
    v_lshlrev_b32 v6, 4, v6
    s_lshl_b32 s48, s22, 5
    v_add_u32 v5, s48, v5
    v_mov_b32 v12, v5
    v_mov_b32 v13, v6
    s_mov_b32 s93, s45
    v_mul_lo_u32 v7, v12, s36
    v_add_u32 v7, v7, v13
    s_mul_i32 s92, s36, 0
    s_sub_u32 s92, s92, 0
    v_add_u32 v20, s92, v7
    s_mul_i32 s92, s36, 4
    s_sub_u32 s92, s92, 1024
    v_add_u32 v21, s92, v7
    s_mul_i32 s92, s36, 16
    s_sub_u32 s92, s92, 2048
    v_add_u32 v22, s92, v7
    s_mul_i32 s92, s36, 20
    s_sub_u32 s92, s92, 3072
    v_add_u32 v23, s92, v7
    s_lshl_b32 s47, s20, 12
    s_lshl_b32 s48, s22, 13
    s_lshl_b32 s49, s21, 12
    s_add_u32 s48, s48, s49
    s_add_u32 s48, s48, 16384
    s_cmp_eq_u32 s46, 1
    s_waitcnt lgkmcnt(0)
    s_cselect_b32 s28, s8, s6
    s_cselect_b32 s29, s9, s7
    s_add_u32 s28, s28, s43
    s_addc_u32 s29, s29, 0
    s_lshl_b32 s30, s36, 9
    s_sub_u32 s30, s30, s43
    s_mov_b32 s31, 0x20000
    s_mov_b32 s84, s4
    s_mov_b32 s85, s5
    s_mov_b32 s86, 2097152
    s_mov_b32 s87, 0x20000
    s_lshl_b32 s38, s36, 6
    s_mov_b32 s39, 196608
    s_and_b32 s23, s18, 7
    s_add_u32 s45, s23, 0
    s_and_b32 s45, s45, 7
    s_lshl_b32 s46, s45, 7
    s_mul_i32 s44, s45, s38
    s_add_u32 s49, s48, 0
    s_add_u32 m0, s47, 0
    s_nop 0
    buffer_load_dwordx4 v16, s[84:87], s46 offen offset:0  lds
    buffer_load_dwordx4 v17, s[84:87], s46 offen offset:1024  lds
    buffer_load_dwordx4 v18, s[84:87], s46 offen offset:2048  lds
    buffer_load_dwordx4 v19, s[84:87], s46 offen offset:3072  lds
    s_mov_b32 m0, s49
    s_nop 0
    buffer_load_dwordx4 v20, s[28:31], s44 offen offset:0  lds
    buffer_load_dwordx4 v21, s[28:31], s44 offen offset:1024  lds
    buffer_load_dwordx4 v22, s[28:31], s44 offen offset:2048  lds
    buffer_load_dwordx4 v23, s[28:31], s44 offen offset:3072  lds
    s_add_u32 s45, s23, 1
    s_and_b32 s45, s45, 7
    s_lshl_b32 s46, s45, 7
    s_mul_i32 s44, s45, s38
    s_add_u32 s49, s48, 32768
    s_add_u32 m0, s47, 32768
    s_nop 0
    buffer_load_dwordx4 v16, s[84:87], s46 offen offset:0  lds
    buffer_load_dwordx4 v17, s[84:87], s46 offen offset:1024  lds
    buffer_load_dwordx4 v18, s[84:87], s46 offen offset:2048  lds
    buffer_load_dwordx4 v19, s[84:87], s46 offen offset:3072  lds
    s_mov_b32 m0, s49
    s_nop 0
    buffer_load_dwordx4 v20, s[28:31], s44 offen offset:0  lds
    buffer_load_dwordx4 v21, s[28:31], s44 offen offset:1024  lds
    buffer_load_dwordx4 v22, s[28:31], s44 offen offset:2048  lds
    buffer_load_dwordx4 v23, s[28:31], s44 offen offset:3072  lds
    s_movk_i32 s37, 3072
    v_mul_lo_u32 v7, v12, s37
    v_add_u32 v7, v7, v13
    s_mul_i32 s92, s37, 0
    s_sub_u32 s92, s92, 0
    v_add_u32 v24, s92, v7
    s_mul_i32 s92, s37, 4
    s_sub_u32 s92, s92, 1024
    v_add_u32 v25, s92, v7
    s_mul_i32 s92, s37, 16
    s_sub_u32 s92, s92, 2048
    v_add_u32 v26, s92, v7
    s_mul_i32 s92, s37, 20
    s_sub_u32 s92, s92, 3072
    v_add_u32 v27, s92, v7
    s_add_u32 s24, s6, s93
    s_addc_u32 s25, s7, 0
    s_mov_b32 s26, 1572864
    s_sub_u32 s26, s26, s93
    s_mov_b32 s27, 0x20000
    s_mov_b32 s32, s14
    s_mov_b32 s33, s15
    s_mov_b32 s34, 22020096
    s_mov_b32 s35, 0x20000
    s_add_u32 s45, s23, 2
    s_and_b32 s45, s45, 7
    s_lshl_b32 s46, s45, 7
    s_mul_i32 s44, s45, s38
    s_add_u32 s49, s48, 65536
    s_add_u32 m0, s47, 65536
    s_waitcnt vmcnt(8)
    s_barrier
    buffer_load_dwordx4 v16, s[84:87], s46 offen offset:0  lds
    buffer_load_dwordx4 v17, s[84:87], s46 offen offset:1024  lds
    buffer_load_dwordx4 v18, s[84:87], s46 offen offset:2048  lds
    buffer_load_dwordx4 v19, s[84:87], s46 offen offset:3072  lds
    s_mov_b32 m0, s49
    s_nop 0
    buffer_load_dwordx4 v20, s[28:31], s44 offen offset:0  lds
    buffer_load_dwordx4 v21, s[28:31], s44 offen offset:1024  lds
    buffer_load_dwordx4 v22, s[28:31], s44 offen offset:2048  lds
    buffer_load_dwordx4 v23, s[28:31], s44 offen offset:3072  lds
    s_add_u32 s45, s23, 3
    s_and_b32 s45, s45, 7
    s_lshl_b32 s46, s45, 7
    s_mul_i32 s44, s45, s38
    s_add_u32 s49, s48, 98304
    s_add_u32 m0, s47, 98304
    s_nop 0
    buffer_load_dwordx4 v16, s[84:87], s46 offen offset:0  lds
    buffer_load_dwordx4 v17, s[84:87], s46 offen offset:1024  lds
    buffer_load_dwordx4 v18, s[84:87], s46 offen offset:2048  lds
    buffer_load_dwordx4 v19, s[84:87], s46 offen offset:3072  lds
    s_mov_b32 m0, s49
    s_nop 0
    buffer_load_dwordx4 v20, s[28:31], s44 offen offset:0  lds
    buffer_load_dwordx4 v21, s[28:31], s44 offen offset:1024  lds
    buffer_load_dwordx4 v22, s[28:31], s44 offen offset:2048  lds
    buffer_load_dwordx4 v23, s[28:31], s44 offen offset:3072  lds
    s_add_u32 s45, s23, 4
    s_and_b32 s45, s45, 7
    s_lshl_b32 s46, s45, 7
    s_mul_i32 s44, s45, s38
    s_add_u32 s49, s48, 0
    s_add_u32 m0, s47, 0
    s_waitcnt vmcnt(16)
    s_barrier
    buffer_load_dwordx4 v16, s[84:87], s46 offen offset:0  lds
    buffer_load_dwordx4 v17, s[84:87], s46 offen offset:1024  lds
    buffer_load_dwordx4 v18, s[84:87], s46 offen offset:2048  lds
    buffer_load_dwordx4 v19, s[84:87], s46 offen offset:3072  lds
    s_mov_b32 m0, s49
    s_nop 0
    buffer_load_dwordx4 v20, s[28:31], s44 offen offset:0  lds
    buffer_load_dwordx4 v21, s[28:31], s44 offen offset:1024  lds
    buffer_load_dwordx4 v22, s[28:31], s44 offen offset:2048  lds
    buffer_load_dwordx4 v23, s[28:31], s44 offen offset:3072  lds
    s_add_u32 s45, s23, 5
    s_and_b32 s45, s45, 7
    s_lshl_b32 s46, s45, 7
    s_mul_i32 s44, s45, s38
    s_add_u32 s49, s48, 32768
    s_add_u32 m0, s47, 32768
    s_waitcnt vmcnt(16)
    s_barrier
    buffer_load_dwordx4 v16, s[84:87], s46 offen offset:0  lds
    buffer_load_dwordx4 v17, s[84:87], s46 offen offset:1024  lds
    buffer_load_dwordx4 v18, s[84:87], s46 offen offset:2048  lds
    buffer_load_dwordx4 v19, s[84:87], s46 offen offset:3072  lds
    s_mov_b32 m0, s49
    s_nop 0
    buffer_load_dwordx4 v20, s[28:31], s44 offen offset:0  lds
    buffer_load_dwordx4 v21, s[28:31], s44 offen offset:1024  lds
    buffer_load_dwordx4 v22, s[28:31], s44 offen offset:2048  lds
    buffer_load_dwordx4 v23, s[28:31], s44 offen offset:3072  lds
    s_add_u32 s45, s23, 6
    s_and_b32 s45, s45, 7
    s_lshl_b32 s46, s45, 7
    s_mul_i32 s44, s45, s38
    s_add_u32 s49, s48, 65536
    s_add_u32 m0, s47, 65536
    s_waitcnt vmcnt(16)
    s_barrier
    buffer_load_dwordx4 v16, s[84:87], s46 offen offset:0  lds
    buffer_load_dwordx4 v17, s[84:87], s46 offen offset:1024  lds
    buffer_load_dwordx4 v18, s[84:87], s46 offen offset:2048  lds
    buffer_load_dwordx4 v19, s[84:87], s46 offen offset:3072  lds
    s_mov_b32 m0, s49
    s_nop 0
    buffer_load_dwordx4 v20, s[28:31], s44 offen offset:0  lds
    buffer_load_dwordx4 v21, s[28:31], s44 offen offset:1024  lds
    buffer_load_dwordx4 v22, s[28:31], s44 offen offset:2048  lds
    buffer_load_dwordx4 v23, s[28:31], s44 offen offset:3072  lds
    s_add_u32 s45, s23, 7
    s_and_b32 s45, s45, 7
    s_lshl_b32 s46, s45, 7
    s_mul_i32 s44, s45, s38
    s_add_u32 s49, s48, 98304
    s_add_u32 m0, s47, 98304
    s_waitcnt vmcnt(16)
    s_barrier
    buffer_load_dwordx4 v16, s[84:87], s46 offen offset:0  lds
    buffer_load_dwordx4 v17, s[84:87], s46 offen offset:1024  lds
    buffer_load_dwordx4 v18, s[84:87], s46 offen offset:2048  lds
    buffer_load_dwordx4 v19, s[84:87], s46 offen offset:3072  lds
    s_mov_b32 m0, s49
    s_nop 0
    buffer_load_dwordx4 v20, s[28:31], s44 offen offset:0  lds
    buffer_load_dwordx4 v21, s[28:31], s44 offen offset:1024  lds
    buffer_load_dwordx4 v22, s[28:31], s44 offen offset:2048  lds
    buffer_load_dwordx4 v23, s[28:31], s44 offen offset:3072  lds
    s_add_u32 s45, s23, 4
    s_and_b32 s45, s45, 7
    s_lshl_b32 s46, s45, 7
    s_mul_i32 s44, s45, s39
    s_add_u32 s49, s48, 0
    s_mov_b32 m0, s49
    s_waitcnt vmcnt(16)
    s_barrier
    buffer_load_dwordx4 v24, s[24:27], s44 offen offset:0  lds
    buffer_load_dwordx4 v25, s[24:27], s44 offen offset:1024  lds
    buffer_load_dwordx4 v26, s[24:27], s44 offen offset:2048  lds
    buffer_load_dwordx4 v27, s[24:27], s44 offen offset:3072  lds
    s_add_u32 s45, s23, 5
    s_and_b32 s45, s45, 7
    s_lshl_b32 s46, s45, 7
    s_mul_i32 s44, s45, s39
    s_add_u32 s49, s48, 32768
    s_mov_b32 m0, s49
    s_waitcnt vmcnt(12)
    s_barrier
    buffer_load_dwordx4 v24, s[24:27], s44 offen offset:0  lds
    buffer_load_dwordx4 v25, s[24:27], s44 offen offset:1024  lds
    buffer_load_dwordx4 v26, s[24:27], s44 offen offset:2048  lds
    buffer_load_dwordx4 v27, s[24:27], s44 offen offset:3072  lds
    s_add_u32 s45, s23, 6
    s_and_b32 s45, s45, 7
    s_lshl_b32 s46, s45, 7
    s_mul_i32 s44, s45, s39
    s_add_u32 s49, s48, 65536
    s_mov_b32 m0, s49
    s_waitcnt vmcnt(8)
    s_barrier
    buffer_load_dwordx4 v24, s[24:27], s44 offen offset:0  lds
    buffer_load_dwordx4 v25, s[24:27], s44 offen offset:1024  lds
    buffer_load_dwordx4 v26, s[24:27], s44 offen offset:2048  lds
    buffer_load_dwordx4 v27, s[24:27], s44 offen offset:3072  lds
    s_add_u32 s45, s23, 7
    s_and_b32 s45, s45, 7
    s_lshl_b32 s46, s45, 7
    s_mul_i32 s44, s45, s39
    s_add_u32 s49, s48, 98304
    s_mov_b32 m0, s49
    s_waitcnt vmcnt(8)
    s_barrier
    buffer_load_dwordx4 v24, s[24:27], s44 offen offset:0  lds
    buffer_load_dwordx4 v25, s[24:27], s44 offen offset:1024  lds
    buffer_load_dwordx4 v26, s[24:27], s44 offen offset:2048  lds
    buffer_load_dwordx4 v27, s[24:27], s44 offen offset:3072  lds
    s_cmp_eq_u32 s19, 14
    s_cbranch_scc1 K1_lpure
    s_lshl_b32 s43, s20, 12
    s_add_u32 s43, s43, 132096
    v_lshlrev_b32 v5, 4, v1
    v_add_u32 v6, s43, v5
    v_mov_b32 v90, 0xc0135761
    v_mov_b32 v91, 0xc0135761
    v_mov_b32 v92, 0xbdd2d3e8
    v_mov_b32 v93, 0xbdd2d3e8
    v_mov_b32 v94, 1.0
    v_mov_b32 v95, 1.0
    s_lshl_b32 s43, s18, 2
    s_lshl_b32 s44, s21, 1
    s_add_u32 s43, s43, s44
    s_mul_i32 s43, s43, 56
    s_lshl_b32 s44, s19, 2
    s_add_u32 s43, s43, s44
    s_lshl_b32 s44, s22, 1
    s_add_u32 s43, s43, s44
    s_lshl_b32 s43, s43, 10
    s_add_u32 s52, s43, 6291456
    s_add_u32 s53, s52, 57344
    s_cmp_lt_u32 s20, 2
    s_cbranch_scc1 K1_lx
    s_add_u32 s45, s23, 0
    s_and_b32 s45, s45, 7
    s_lshl_b32 s46, s45, 7
    s_mul_i32 s44, s45, s39
    s_add_u32 s49, s48, 0
    s_add_u32 m0, s47, 0
    s_waitcnt vmcnt(8)
    s_barrier
    buffer_load_dwordx4 v16, s[84:87], s46 offen offset:0  lds
    buffer_load_dwordx4 v17, s[84:87], s46 offen offset:1024  lds
    buffer_load_dwordx4 v18, s[84:87], s46 offen offset:2048  lds
    buffer_load_dwordx4 v19, s[84:87], s46 offen offset:3072  lds
    s_mov_b32 m0, s49
    s_nop 0
    buffer_load_dwordx4 v24, s[24:27], s44 offen offset:0  lds
    buffer_load_dwordx4 v25, s[24:27], s44 offen offset:1024  lds
    buffer_load_dwordx4 v26, s[24:27], s44 offen offset:2048  lds
    buffer_load_dwordx4 v27, s[24:27], s44 offen offset:3072  lds
    s_add_u32 s45, s23, 1
    s_and_b32 s45, s45, 7
    s_lshl_b32 s46, s45, 7
    s_mul_i32 s44, s45, s39
    s_add_u32 s49, s48, 32768
    s_add_u32 m0, s47, 32768
    s_waitcnt vmcnt(12)
    s_barrier
    buffer_load_dwordx4 v16, s[84:87], s46 offen offset:0  lds
    buffer_load_dwordx4 v17, s[84:87], s46 offen offset:1024  lds
    buffer_load_dwordx4 v18, s[84:87], s46 offen offset:2048  lds
    buffer_load_dwordx4 v19, s[84:87], s46 offen offset:3072  lds
    s_mov_b32 m0, s49
    s_nop 0
    buffer_load_dwordx4 v24, s[24:27], s44 offen offset:0  lds
    buffer_load_dwordx4 v25, s[24:27], s44 offen offset:1024  lds
    buffer_load_dwordx4 v26, s[24:27], s44 offen offset:2048  lds
    buffer_load_dwordx4 v27, s[24:27], s44 offen offset:3072  lds
    s_add_u32 s45, s23, 2
    s_and_b32 s45, s45, 7
    s_lshl_b32 s46, s45, 7
    s_mul_i32 s44, s45, s39
    s_add_u32 s49, s48, 65536
    s_add_u32 m0, s47, 65536
    s_waitcnt vmcnt(16)
    s_barrier
    buffer_load_dwordx4 v16, s[84:87], s46 offen offset:0  lds
    buffer_load_dwordx4 v17, s[84:87], s46 offen offset:1024  lds
    buffer_load_dwordx4 v18, s[84:87], s46 offen offset:2048  lds
    buffer_load_dwordx4 v19, s[84:87], s46 offen offset:3072  lds
    s_mov_b32 m0, s49
    s_nop 0
    buffer_load_dwordx4 v24, s[24:27], s44 offen offset:0  lds
    buffer_load_dwordx4 v25, s[24:27], s44 offen offset:1024  lds
    buffer_load_dwordx4 v26, s[24:27], s44 offen offset:2048  lds
    buffer_load_dwordx4 v27, s[24:27], s44 offen offset:3072  lds
    s_add_u32 s45, s23, 3
    s_and_b32 s45, s45, 7
    s_lshl_b32 s46, s45, 7
    s_mul_i32 s44, s45, s39
    s_add_u32 s49, s48, 98304
    s_add_u32 m0, s47, 98304
    s_waitcnt vmcnt(16)
    s_barrier
    buffer_load_dwordx4 v16, s[84:87], s46 offen offset:0  lds
    buffer_load_dwordx4 v17, s[84:87], s46 offen offset:1024  lds
    buffer_load_dwordx4 v18, s[84:87], s46 offen offset:2048  lds
    buffer_load_dwordx4 v19, s[84:87], s46 offen offset:3072  lds
    s_mov_b32 m0, s49
    s_nop 0
    buffer_load_dwordx4 v24, s[24:27], s44 offen offset:0  lds
    buffer_load_dwordx4 v25, s[24:27], s44 offen offset:1024  lds
    buffer_load_dwordx4 v26, s[24:27], s44 offen offset:2048  lds
    buffer_load_dwordx4 v27, s[24:27], s44 offen offset:3072  lds
    s_branch K1_lb12m
K1_lpure:
    s_add_u32 s45, s23, 0
    s_and_b32 s45, s45, 7
    s_lshl_b32 s46, s45, 7
    s_mul_i32 s44, s45, s39
    s_add_u32 s49, s48, 0
    s_add_u32 m0, s47, 0
    s_waitcnt vmcnt(8)
    s_barrier
    buffer_load_dwordx4 v16, s[84:87], s46 offen offset:0  lds
    buffer_load_dwordx4 v17, s[84:87], s46 offen offset:1024  lds
    buffer_load_dwordx4 v18, s[84:87], s46 offen offset:2048  lds
    buffer_load_dwordx4 v19, s[84:87], s46 offen offset:3072  lds
    s_mov_b32 m0, s49
    s_nop 0
    buffer_load_dwordx4 v24, s[24:27], s44 offen offset:0  lds
    buffer_load_dwordx4 v25, s[24:27], s44 offen offset:1024  lds
    buffer_load_dwordx4 v26, s[24:27], s44 offen offset:2048  lds
    buffer_load_dwordx4 v27, s[24:27], s44 offen offset:3072  lds
    s_add_u32 s45, s23, 1
    s_and_b32 s45, s45, 7
    s_lshl_b32 s46, s45, 7
    s_mul_i32 s44, s45, s39
    s_add_u32 s49, s48, 32768
    s_add_u32 m0, s47, 32768
    s_waitcnt vmcnt(12)
    s_barrier
    buffer_load_dwordx4 v16, s[84:87], s46 offen offset:0  lds
    buffer_load_dwordx4 v17, s[84:87], s46 offen offset:1024  lds
    buffer_load_dwordx4 v18, s[84:87], s46 offen offset:2048  lds
    buffer_load_dwordx4 v19, s[84:87], s46 offen offset:3072  lds
    s_mov_b32 m0, s49
    s_nop 0
    buffer_load_dwordx4 v24, s[24:27], s44 offen offset:0  lds
    buffer_load_dwordx4 v25, s[24:27], s44 offen offset:1024  lds
    buffer_load_dwordx4 v26, s[24:27], s44 offen offset:2048  lds
    buffer_load_dwordx4 v27, s[24:27], s44 offen offset:3072  lds
    s_add_u32 s45, s23, 2
    s_and_b32 s45, s45, 7
    s_lshl_b32 s46, s45, 7
    s_mul_i32 s44, s45, s39
    s_add_u32 s49, s48, 65536
    s_add_u32 m0, s47, 65536
    s_waitcnt vmcnt(16)
    s_barrier
    buffer_load_dwordx4 v16, s[84:87], s46 offen offset:0  lds
    buffer_load_dwordx4 v17, s[84:87], s46 offen offset:1024  lds
    buffer_load_dwordx4 v18, s[84:87], s46 offen offset:2048  lds
    buffer_load_dwordx4 v19, s[84:87], s46 offen offset:3072  lds
    s_mov_b32 m0, s49
    s_nop 0
    buffer_load_dwordx4 v24, s[24:27], s44 offen offset:0  lds
    buffer_load_dwordx4 v25, s[24:27], s44 offen offset:1024  lds
    buffer_load_dwordx4 v26, s[24:27], s44 offen offset:2048  lds
    buffer_load_dwordx4 v27, s[24:27], s44 offen offset:3072  lds
    s_add_u32 s45, s23, 3
    s_and_b32 s45, s45, 7
    s_lshl_b32 s46, s45, 7
    s_mul_i32 s44, s45, s39
    s_add_u32 s49, s48, 98304
    s_add_u32 m0, s47, 98304
    s_waitcnt vmcnt(16)
    s_barrier
    buffer_load_dwordx4 v16, s[84:87], s46 offen offset:0  lds
    buffer_load_dwordx4 v17, s[84:87], s46 offen offset:1024  lds
    buffer_load_dwordx4 v18, s[84:87], s46 offen offset:2048  lds
    buffer_load_dwordx4 v19, s[84:87], s46 offen offset:3072  lds
    s_mov_b32 m0, s49
    s_nop 0
    buffer_load_dwordx4 v24, s[24:27], s44 offen offset:0  lds
    buffer_load_dwordx4 v25, s[24:27], s44 offen offset:1024  lds
    buffer_load_dwordx4 v26, s[24:27], s44 offen offset:2048  lds
    buffer_load_dwordx4 v27, s[24:27], s44 offen offset:3072  lds
K1_lb12m:
    s_mov_b32 s80, s10
    s_mov_b32 s81, s11
    s_mov_b32 s82, 8388608
    s_mov_b32 s83, 0x20000
    s_lshr_b32 s43, s16, 1
    s_lshl_b32 s43, s43, 21
    s_lshl_b32 s44, s17, 16
    s_add_u32 s43, s43, s44
    s_and_b32 s44, s16, 1
    s_lshl_b32 s44, s44, 11
    s_add_u32 s43, s43, s44
    s_and_b32 s44, s20, 1
    s_lshl_b32 s44, s44, 15
    s_add_u32 s43, s43, s44
    v_and_b32 v8, 63, v1
    v_lshlrev_b32 v8, 4, v8
    s_waitcnt vmcnt(16)
    s_barrier
    buffer_load_dwordx4 v[64:67], v8, s[80:83], s43 offen offset:0
    buffer_load_dwordx4 v[68:71], v8, s[80:83], s43 offen offset:1024
    s_add_u32 s43, s43, 4096
    buffer_load_dwordx4 v[72:75], v8, s[80:83], s43 offen offset:0
    buffer_load_dwordx4 v[76:79], v8, s[80:83], s43 offen offset:1024
    s_add_u32 s43, s43, 4096
    s_waitcnt vmcnt(12)
    s_barrier
    buffer_load_dwordx4 v[64:67], v8, s[80:83], s43 offen offset:0
    buffer_load_dwordx4 v[68:71], v8, s[80:83], s43 offen offset:1024
    s_add_u32 s43, s43, 4096
    buffer_load_dwordx4 v[72:75], v8, s[80:83], s43 offen offset:0
    buffer_load_dwordx4 v[76:79], v8, s[80:83], s43 offen offset:1024
    s_add_u32 s43, s43, 4096
    s_waitcnt vmcnt(8)
    s_barrier
    buffer_load_dwordx4 v[64:67], v8, s[80:83], s43 offen offset:0
    buffer_load_dwordx4 v[68:71], v8, s[80:83], s43 offen offset:1024
    s_add_u32 s43, s43, 4096
    buffer_load_dwordx4 v[72:75], v8, s[80:83], s43 offen offset:0
    buffer_load_dwordx4 v[76:79], v8, s[80:83], s43 offen offset:1024
    s_add_u32 s43, s43, 4096
    s_barrier
    buffer_load_dwordx4 v[64:67], v8, s[80:83], s43 offen offset:0
    buffer_load_dwordx4 v[68:71], v8, s[80:83], s43 offen offset:1024
    s_add_u32 s43, s43, 4096
    buffer_load_dwordx4 v[72:75], v8, s[80:83], s43 offen offset:0
    buffer_load_dwordx4 v[76:79], v8, s[80:83], s43 offen offset:1024
    s_add_u32 s43, s43, 4096
    s_waitcnt vmcnt(0)
    s_branch K1_fin
K1_lx:
    s_lshl_b32 s43, s20, 6
    v_add_u32 v9, s43, v1
    v_lshlrev_b32 v7, 4, v9
    s_mul_i32 s54, s18, 28672
    s_add_u32 s54, s54, 20971520
    s_mov_b32 s88, 0
    s_add_u32 s45, s23, 0
    s_and_b32 s45, s45, 7
    s_lshl_b32 s46, s45, 7
    s_mul_i32 s44, s45, s39
    s_add_u32 s49, s48, 0
    s_add_u32 m0, s47, 0
    s_waitcnt vmcnt(8)
    s_barrier
    buffer_load_dwordx4 v16, s[84:87], s46 offen offset:0  lds
    buffer_load_dwordx4 v17, s[84:87], s46 offen offset:1024  lds
    buffer_load_dwordx4 v18, s[84:87], s46 offen offset:2048  lds
    buffer_load_dwordx4 v19, s[84:87], s46 offen offset:3072  lds
    s_mov_b32 m0, s49
    s_nop 0
    buffer_load_dwordx4 v24, s[24:27], s44 offen offset:0  lds
    buffer_load_dwordx4 v25, s[24:27], s44 offen offset:1024  lds
    buffer_load_dwordx4 v26, s[24:27], s44 offen offset:2048  lds
    buffer_load_dwordx4 v27, s[24:27], s44 offen offset:3072  lds
    s_add_u32 s45, s23, 1
    s_and_b32 s45, s45, 7
    s_lshl_b32 s46, s45, 7
    s_mul_i32 s44, s45, s39
    s_add_u32 s49, s48, 32768
    s_add_u32 m0, s47, 32768
    s_waitcnt vmcnt(12)
    s_barrier
    buffer_load_dwordx4 v16, s[84:87], s46 offen offset:0  lds
    buffer_load_dwordx4 v17, s[84:87], s46 offen offset:1024  lds
    buffer_load_dwordx4 v18, s[84:87], s46 offen offset:2048  lds
    buffer_load_dwordx4 v19, s[84:87], s46 offen offset:3072  lds
    s_mov_b32 m0, s49
    s_nop 0
    buffer_load_dwordx4 v24, s[24:27], s44 offen offset:0  lds
    buffer_load_dwordx4 v25, s[24:27], s44 offen offset:1024  lds
    buffer_load_dwordx4 v26, s[24:27], s44 offen offset:2048  lds
    buffer_load_dwordx4 v27, s[24:27], s44 offen offset:3072  lds
    s_add_u32 s45, s23, 2
    s_and_b32 s45, s45, 7
    s_lshl_b32 s46, s45, 7
    s_mul_i32 s44, s45, s39
    s_add_u32 s49, s48, 65536
    s_add_u32 m0, s47, 65536
    s_waitcnt vmcnt(16)
    s_barrier
    buffer_load_dwordx4 v16, s[84:87], s46 offen offset:0  lds
    buffer_load_dwordx4 v17, s[84:87], s46 offen offset:1024  lds
    buffer_load_dwordx4 v18, s[84:87], s46 offen offset:2048  lds
    buffer_load_dwordx4 v19, s[84:87], s46 offen offset:3072  lds
    s_mov_b32 m0, s49
    s_nop 0
    buffer_load_dwordx4 v24, s[24:27], s44 offen offset:0  lds
    buffer_load_dwordx4 v25, s[24:27], s44 offen offset:1024  lds
    buffer_load_dwordx4 v26, s[24:27], s44 offen offset:2048  lds
    buffer_load_dwordx4 v27, s[24:27], s44 offen offset:3072  lds
    s_mov_b32 s43, s54
    buffer_load_dwordx4 v[96:99], v7, s[32:35], s43 offen offset:0 sc1
    buffer_load_dwordx4 v[100:103], v7, s[32:35], s43 offen offset:2048 sc1
    s_add_u32 s43, s43, 4096
    buffer_load_dwordx4 v[104:107], v7, s[32:35], s43 offen offset:0 sc1
    buffer_load_dwordx4 v[108:111], v7, s[32:35], s43 offen offset:2048 sc1
    s_add_u32 s43, s43, 4096
    buffer_load_dwordx4 v[112:115], v7, s[32:35], s43 offen offset:0 sc1
    buffer_load_dwordx4 v[116:119], v7, s[32:35], s43 offen offset:2048 sc1
    s_add_u32 s43, s43, 4096
    buffer_load_dwordx4 v[120:123], v7, s[32:35], s43 offen offset:0 sc1
    buffer_load_dwordx4 v[124:127], v7, s[32:35], s43 offen offset:2048 sc1
    s_add_u32 s43, s43, 4096
    buffer_load_dwordx4 v[128:131], v7, s[32:35], s43 offen offset:0 sc1
    buffer_load_dwordx4 v[132:135], v7, s[32:35], s43 offen offset:2048 sc1
    s_add_u32 s43, s43, 4096
    buffer_load_dwordx4 v[136:139], v7, s[32:35], s43 offen offset:0 sc1
    buffer_load_dwordx4 v[140:143], v7, s[32:35], s43 offen offset:2048 sc1
    s_add_u32 s43, s43, 4096
    buffer_load_dwordx4 v[144:147], v7, s[32:35], s43 offen offset:0 sc1
    buffer_load_dwordx4 v[148:151], v7, s[32:35], s43 offen offset:2048 sc1
    s_add_u32 s45, s23, 3
    s_and_b32 s45, s45, 7
    s_lshl_b32 s46, s45, 7
    s_mul_i32 s44, s45, s39
    s_add_u32 s49, s48, 98304
    s_add_u32 m0, s47, 98304
    s_waitcnt vmcnt(30)
    s_barrier
    buffer_load_dwordx4 v16, s[84:87], s46 offen offset:0  lds
    buffer_load_dwordx4 v17, s[84:87], s46 offen offset:1024  lds
    buffer_load_dwordx4 v18, s[84:87], s46 offen offset:2048  lds
    buffer_load_dwordx4 v19, s[84:87], s46 offen offset:3072  lds
    s_mov_b32 m0, s49
    s_nop 0
    buffer_load_dwordx4 v24, s[24:27], s44 offen offset:0  lds
    buffer_load_dwordx4 v25, s[24:27], s44 offen offset:1024  lds
    buffer_load_dwordx4 v26, s[24:27], s44 offen offset:2048  lds
    buffer_load_dwordx4 v27, s[24:27], s44 offen offset:3072  lds
    s_waitcnt vmcnt(30)
    s_barrier
    s_waitcnt vmcnt(8)
    s_branch K1_pchk1
K1_pchk:
    s_waitcnt vmcnt(0)
K1_pchk1:
    v_max_u32 v10, v96, v97
    v_max3_u32 v10, v10, v98, v99
    v_max3_u32 v10, v10, v100, v101
    v_max3_u32 v10, v10, v102, v103
    v_max3_u32 v10, v10, v104, v105
    v_max3_u32 v10, v10, v106, v107
    v_max3_u32 v10, v10, v108, v109
    v_max3_u32 v10, v10, v110, v111
    v_max3_u32 v10, v10, v112, v113
    v_max3_u32 v10, v10, v114, v115
    v_max3_u32 v10, v10, v116, v117
    v_max3_u32 v10, v10, v118, v119
    v_max3_u32 v10, v10, v120, v121
    v_max3_u32 v10, v10, v122, v123
    v_max3_u32 v10, v10, v124, v125
    v_max3_u32 v10, v10, v126, v127
    v_max3_u32 v10, v10, v128, v129
    v_max3_u32 v10, v10, v130, v131
    v_max3_u32 v10, v10, v132, v133
    v_max3_u32 v10, v10, v134, v135
    v_max3_u32 v10, v10, v136, v137
    v_max3_u32 v10, v10, v138, v139
    v_max3_u32 v10, v10, v140, v141
    v_max3_u32 v10, v10, v142, v143
    v_max3_u32 v10, v10, v144, v145
    v_max3_u32 v10, v10, v146, v147
    v_max3_u32 v10, v10, v148, v149
    v_max3_u32 v10, v10, v150, v151
    v_cmp_eq_u32 vcc, -1, v10
    s_add_u32 s88, s88, 1
    s_cmp_ge_u32 s88, 0x20000
    s_cbranch_scc1 K1_polled
    s_cbranch_vccz K1_polled
    s_mov_b32 s43, s54
    buffer_load_dwordx4 v[96:99], v7, s[32:35], s43 offen offset:0 sc1
    buffer_load_dwordx4 v[100:103], v7, s[32:35], s43 offen offset:2048 sc1
    s_add_u32 s43, s43, 4096
    buffer_load_dwordx4 v[104:107], v7, s[32:35], s43 offen offset:0 sc1
    buffer_load_dwordx4 v[108:111], v7, s[32:35], s43 offen offset:2048 sc1
    s_add_u32 s43, s43, 4096
    buffer_load_dwordx4 v[112:115], v7, s[32:35], s43 offen offset:0 sc1
    buffer_load_dwordx4 v[116:119], v7, s[32:35], s43 offen offset:2048 sc1
    s_add_u32 s43, s43, 4096
    buffer_load_dwordx4 v[120:123], v7, s[32:35], s43 offen offset:0 sc1
    buffer_load_dwordx4 v[124:127], v7, s[32:35], s43 offen offset:2048 sc1
    s_add_u32 s43, s43, 4096
    buffer_load_dwordx4 v[128:131], v7, s[32:35], s43 offen offset:0 sc1
    buffer_load_dwordx4 v[132:135], v7, s[32:35], s43 offen offset:2048 sc1
    s_add_u32 s43, s43, 4096
    buffer_load_dwordx4 v[136:139], v7, s[32:35], s43 offen offset:0 sc1
    buffer_load_dwordx4 v[140:143], v7, s[32:35], s43 offen offset:2048 sc1
    s_add_u32 s43, s43, 4096
    buffer_load_dwordx4 v[144:147], v7, s[32:35], s43 offen offset:0 sc1
    buffer_load_dwordx4 v[148:151], v7, s[32:35], s43 offen offset:2048 sc1
    s_branch K1_pchk
K1_polled:
    v_pk_add_f32 v[96:97], v[96:97], v[98:99]
    v_pk_add_f32 v[96:97], v[96:97], v[100:101]
    v_pk_add_f32 v[96:97], v[96:97], v[102:103]
    v_pk_add_f32 v[96:97], v[96:97], v[104:105]
    v_pk_add_f32 v[96:97], v[96:97], v[106:107]
    v_pk_add_f32 v[96:97], v[96:97], v[108:109]
    v_pk_add_f32 v[96:97], v[96:97], v[110:111]
    v_pk_add_f32 v[96:97], v[96:97], v[112:113]
    v_pk_add_f32 v[96:97], v[96:97], v[114:115]
    v_pk_add_f32 v[96:97], v[96:97], v[116:117]
    v_pk_add_f32 v[96:97], v[96:97], v[118:119]
    v_pk_add_f32 v[96:97], v[96:97], v[120:121]
    v_pk_add_f32 v[96:97], v[96:97], v[122:123]
    v_pk_add_f32 v[96:97], v[96:97], v[124:125]
    v_pk_add_f32 v[96:97], v[96:97], v[126:127]
    v_pk_add_f32 v[96:97], v[96:97], v[128:129]
    v_pk_add_f32 v[96:97], v[96:97], v[130:131]
    v_pk_add_f32 v[96:97], v[96:97], v[132:133]
    v_pk_add_f32 v[96:97], v[96:97], v[134:135]
    v_pk_add_f32 v[96:97], v[96:97], v[136:137]
    v_pk_add_f32 v[96:97], v[96:97], v[138:139]
    v_pk_add_f32 v[96:97], v[96:97], v[140:141]
    v_pk_add_f32 v[96:97], v[96:97], v[142:143]
    v_pk_add_f32 v[96:97], v[96:97], v[144:145]
    v_pk_add_f32 v[96:97], v[96:97], v[146:147]
    v_pk_add_f32 v[96:97], v[96:97], v[148:149]
    v_pk_add_f32 v[96:97], v[96:97], v[150:151]
    v_mul_f32 v96, 0x3a924925, v96
    v_mul_f32 v97, 0x3a924925, v97
    v_fma_f32 v97, -v96, v96, v97
    v_max_f32 v97, 0, v97
    v_add_f32 v97, 0x3727c5ac, v97
    v_rsq_f32 v97, v97
    s_nop 0
    v_mul_f32 v96, v96, v97
    v_sub_f32 v96, 0, v96
    v_lshlrev_b32 v7, 3, v9
    v_add_u32 v7, 131072, v7
    ds_write_b64 v7, v[96:97]
    s_waitcnt lgkmcnt(0)
    s_barrier
    s_waitcnt vmcnt(0)
    s_barrier
    s_barrier
    s_branch K1_fin
K1_compute:
    s_lshr_b32 s21, s20, 1
    s_and_b32 s22, s20, 1
    s_mul_i32 s43, s18, 14
    s_add_u32 s43, s43, s19
    s_lshl_b32 s43, s43, 11
    s_lshl_b32 s44, s21, 10
    s_add_u32 s43, s43, s44
    s_lshl_b32 s44, s22, 3
    s_add_u32 s43, s43, s44
    s_add_u32 s62, s43, 20971520
    v_and_b32 v2, 15, v1
    v_lshrrev_b32 v3, 4, v1
    v_lshrrev_b32 v4, 1, v2
    v_xor_b32 v4, v4, v3
    s_lshl_b32 s43, s21, 6
    v_add_u32 v5, s43, v2
    v_lshlrev_b32 v5, 7, v5
    v_lshl_add_u32 v216, v4, 4, v5
    v_xor_b32 v217, 64, v216
    v_lshrrev_b32 v4, 2, v1
    v_and_b32 v4, 7, v4
    v_lshrrev_b32 v5, 5, v1
    v_lshlrev_b32 v5, 11, v5
    v_lshl_add_u32 v5, v4, 7, v5
    v_lshrrev_b32 v4, 1, v4
    v_lshl_add_u32 v5, v4, 5, v5
    v_and_b32 v4, 3, v1
    v_lshl_add_u32 v5, v4, 3, v5
    s_and_b32 s48, s19, 1
    s_lshl_b32 s48, s48, 1
    s_mul_i32 s49, s22, 3
    s_add_u32 s48, s48, s49
    s_lshl_b32 s49, s22, 1
    s_lshl_b32 s50, s22, 2
    s_add_u32 s43, s49, 0
    s_add_u32 s44, s50, 0
    s_cmp_eq_u32 s19, 14
    s_cselect_b32 s43, s44, s43
    s_and_b32 s44, s43, 3
    s_lshl_b32 s44, s44, 5
    s_lshr_b32 s43, s43, 2
    s_lshl_b32 s43, s43, 12
    s_add_u32 s43, s43, 16384
    v_xor_b32 v218, s44, v5
    v_add_u32 v218, s43, v218
    s_add_u32 s43, s49, 1
    s_add_u32 s44, s50, 1
    s_cmp_eq_u32 s19, 14
    s_cselect_b32 s43, s44, s43
    s_and_b32 s44, s43, 3
    s_lshl_b32 s44, s44, 5
    s_lshr_b32 s43, s43, 2
    s_lshl_b32 s43, s43, 12
    s_add_u32 s43, s43, 16384
    v_xor_b32 v219, s44, v5
    v_add_u32 v219, s43, v219
    s_add_u32 s43, s49, 4
    s_add_u32 s44, s50, 2
    s_cmp_eq_u32 s19, 14
    s_cselect_b32 s43, s44, s43
    s_and_b32 s44, s43, 3
    s_lshl_b32 s44, s44, 5
    s_lshr_b32 s43, s43, 2
    s_lshl_b32 s43, s43, 12
    s_add_u32 s43, s43, 16384
    v_xor_b32 v220, s44, v5
    v_add_u32 v220, s43, v220
    s_add_u32 s43, s49, 5
    s_add_u32 s44, s50, 3
    s_cmp_eq_u32 s19, 14
    s_cselect_b32 s43, s44, s43
    s_and_b32 s44, s43, 3
    s_lshl_b32 s44, s44, 5
    s_lshr_b32 s43, s43, 2
    s_lshl_b32 s43, s43, 12
    s_add_u32 s43, s43, 16384
    v_xor_b32 v221, s44, v5
    v_add_u32 v221, s43, v221
    s_add_u32 s43, s48, 0
    s_add_u32 s44, s49, 0
    s_cmp_eq_u32 s19, 14
    s_cselect_b32 s43, s44, s43
    s_and_b32 s44, s43, 3
    s_lshl_b32 s44, s44, 5
    s_lshr_b32 s43, s43, 2
    s_lshl_b32 s43, s43, 12
    s_add_u32 s43, s43, 16384
    v_xor_b32 v222, s44, v5
    v_add_u32 v222, s43, v222
    s_add_u32 s43, s48, 1
    s_add_u32 s44, s49, 1
    s_cmp_eq_u32 s19, 14
    s_cselect_b32 s43, s44, s43
    s_and_b32 s44, s43, 3
    s_lshl_b32 s44, s44, 5
    s_lshr_b32 s43, s43, 2
    s_lshl_b32 s43, s43, 12
    s_add_u32 s43, s43, 16384
    v_xor_b32 v223, s44, v5
    v_add_u32 v223, s43, v223
    s_add_u32 s43, s48, 2
    s_add_u32 s44, s49, 1
    s_cmp_eq_u32 s19, 14
    s_cselect_b32 s43, s44, s43
    s_and_b32 s44, s43, 3
    s_lshl_b32 s44, s44, 5
    s_lshr_b32 s43, s43, 2
    s_lshl_b32 s43, s43, 12
    s_add_u32 s43, s43, 16384
    v_xor_b32 v224, s44, v5
    v_add_u32 v224, s43, v224
    v_mov_b32 v16, 0
    v_mov_b32 v17, 0
    v_mov_b32 v18, 0
    v_mov_b32 v19, 0
    v_mov_b32 v20, 0
    v_mov_b32 v21, 0
    v_mov_b32 v22, 0
    v_mov_b32 v23, 0
    v_mov_b32 v24, 0
    v_mov_b32 v25, 0
    v_mov_b32 v26, 0
    v_mov_b32 v27, 0
    v_mov_b32 v28, 0
    v_mov_b32 v29, 0
    v_mov_b32 v30, 0
    v_mov_b32 v31, 0
    v_mov_b32 v32, 0
    v_mov_b32 v33, 0
    v_mov_b32 v34, 0
    v_mov_b32 v35, 0
    v_mov_b32 v36, 0
    v_mov_b32 v37, 0
    v_mov_b32 v38, 0
    v_mov_b32 v39, 0
    v_mov_b32 v40, 0
    v_mov_b32 v41, 0
    v_mov_b32 v42, 0
    v_mov_b32 v43, 0
    v_mov_b32 v44, 0
    v_mov_b32 v45, 0
    v_mov_b32 v46, 0
    v_mov_b32 v47, 0
    v_mov_b32 v48, 0
    v_mov_b32 v49, 0
    v_mov_b32 v50, 0
    v_mov_b32 v51, 0
    v_mov_b32 v52, 0
    v_mov_b32 v53, 0
    v_mov_b32 v54, 0
    v_mov_b32 v55, 0
    v_mov_b32 v56, 0
    v_mov_b32 v57, 0
    v_mov_b32 v58, 0
    v_mov_b32 v59, 0
    v_mov_b32 v60, 0
    v_mov_b32 v61, 0
    v_mov_b32 v62, 0
    v_mov_b32 v63, 0
    v_mov_b32 v64, 0
    v_mov_b32 v65, 0
    v_mov_b32 v66, 0
    v_mov_b32 v67, 0
    v_mov_b32 v68, 0
    v_mov_b32 v69, 0
    v_mov_b32 v70, 0
    v_mov_b32 v71, 0
    v_mov_b32 v72, 0
    v_mov_b32 v73, 0
    v_mov_b32 v74, 0
    v_mov_b32 v75, 0
    v_mov_b32 v76, 0
    v_mov_b32 v77, 0
    v_mov_b32 v78, 0
    v_mov_b32 v79, 0
    v_mov_b32 v80, 0
    v_mov_b32 v81, 0
    v_mov_b32 v82, 0
    v_mov_b32 v83, 0
    v_mov_b32 v84, 0
    v_mov_b32 v85, 0
    v_mov_b32 v86, 0
    v_mov_b32 v87, 0
    v_mov_b32 v88, 0
    v_mov_b32 v89, 0
    v_mov_b32 v90, 0
    v_mov_b32 v91, 0
    v_mov_b32 v92, 0
    v_mov_b32 v93, 0
    v_mov_b32 v94, 0
    v_mov_b32 v95, 0
    v_mov_b32 v96, 0
    v_mov_b32 v97, 0
    v_mov_b32 v98, 0
    v_mov_b32 v99, 0
    v_mov_b32 v100, 0
    v_mov_b32 v101, 0
    v_mov_b32 v102, 0
    v_mov_b32 v103, 0
    v_mov_b32 v104, 0
    v_mov_b32 v105, 0
    v_mov_b32 v106, 0
    v_mov_b32 v107, 0
    v_mov_b32 v108, 0
    v_mov_b32 v109, 0
    v_mov_b32 v110, 0
    v_mov_b32 v111, 0
    v_mov_b32 v112, 0
    v_mov_b32 v113, 0
    v_mov_b32 v114, 0
    v_mov_b32 v115, 0
    v_mov_b32 v116, 0
    v_mov_b32 v117, 0
    v_mov_b32 v118, 0
    v_mov_b32 v119, 0
    v_mov_b32 v120, 0
    v_mov_b32 v121, 0
    v_mov_b32 v122, 0
    v_mov_b32 v123, 0
    v_mov_b32 v124, 0
    v_mov_b32 v125, 0
    v_mov_b32 v126, 0
    v_mov_b32 v127, 0
    s_mov_b32 s40, 0
    s_mov_b32 s41, 0
    s_waitcnt lgkmcnt(0)
    s_mov_b32 s32, s14
    s_mov_b32 s33, s15
    s_mov_b32 s34, 22020096
    s_mov_b32 s35, 0x20000
    s_barrier
    ds_read_b128 v[128:131], v216 offset:0
    ds_read_b128 v[132:135], v216 offset:2048
    ds_read_b128 v[136:139], v216 offset:4096
    ds_read_b128 v[140:143], v216 offset:6144
    ds_read_b64_tr_b16 v[160:161], v218 offset:0
    ds_read_b64_tr_b16 v[162:163], v218 offset:1024
    ds_read_b64_tr_b16 v[164:165], v219 offset:0
    ds_read_b64_tr_b16 v[166:167], v219 offset:1024
    ds_read_b64_tr_b16 v[168:169], v220 offset:0
    ds_read_b64_tr_b16 v[170:171], v220 offset:1024
    ds_read_b64_tr_b16 v[172:173], v221 offset:0
    ds_read_b64_tr_b16 v[174:175], v221 offset:1024
    s_waitcnt lgkmcnt(0)
.p2align 6
K1_loop0:
    v_mfma_f32_16x16x32_bf16 v[16:19], v[160:163], v[128:131], v[16:19]
    ds_read_b128 v[144:147], v217 offset:0
    ds_read_b128 v[148:151], v217 offset:2048
    v_mfma_f32_16x16x32_bf16 v[20:23], v[160:163], v[132:135], v[20:23]
    ds_read_b128 v[152:155], v217 offset:4096
    ds_read_b128 v[156:159], v217 offset:6144
    v_mfma_f32_16x16x32_bf16 v[24:27], v[160:163], v[136:139], v[24:27]
    ds_read_b64_tr_b16 v[176:177], v218 offset:8192
    ds_read_b64_tr_b16 v[178:179], v218 offset:9216
    v_mfma_f32_16x16x32_bf16 v[28:31], v[160:163], v[140:143], v[28:31]
    ds_read_b64_tr_b16 v[180:181], v219 offset:8192
    ds_read_b64_tr_b16 v[182:183], v219 offset:9216
    v_mfma_f32_16x16x32_bf16 v[32:35], v[164:167], v[128:131], v[32:35]
    ds_read_b64_tr_b16 v[184:185], v220 offset:8192
    ds_read_b64_tr_b16 v[186:187], v220 offset:9216
    v_mfma_f32_16x16x32_bf16 v[36:39], v[164:167], v[132:135], v[36:39]
    ds_read_b64_tr_b16 v[188:189], v221 offset:8192
    ds_read_b64_tr_b16 v[190:191], v221 offset:9216
    v_mfma_f32_16x16x32_bf16 v[40:43], v[164:167], v[136:139], v[40:43]
    s_cmp_eq_u32 s41, 3
    s_mov_b32 s51, 32768
    v_mfma_f32_16x16x32_bf16 v[44:47], v[164:167], v[140:143], v[44:47]
    s_cselect_b32 s51, 4294868992, s51
    s_add_u32 s41, s41, 1
    v_mfma_f32_16x16x32_bf16 v[48:51], v[168:171], v[128:131], v[48:51]
    s_and_b32 s41, s41, 3
    s_add_u32 s40, s40, 1
    v_mfma_f32_16x16x32_bf16 v[52:55], v[168:171], v[132:135], v[52:55]
    v_mfma_f32_16x16x32_bf16 v[56:59], v[168:171], v[136:139], v[56:59]
    v_mfma_f32_16x16x32_bf16 v[60:63], v[168:171], v[140:143], v[60:63]
    v_mfma_f32_16x16x32_bf16 v[64:67], v[172:175], v[128:131], v[64:67]
    v_mfma_f32_16x16x32_bf16 v[68:71], v[172:175], v[132:135], v[68:71]
    v_mfma_f32_16x16x32_bf16 v[72:75], v[172:175], v[136:139], v[72:75]
    v_mfma_f32_16x16x32_bf16 v[76:79], v[172:175], v[140:143], v[76:79]
    s_waitcnt lgkmcnt(0)
    s_barrier
    v_mfma_f32_16x16x32_bf16 v[16:19], v[176:179], v[144:147], v[16:19]
    v_add_u32 v216, s51, v216
    ds_read_b128 v[128:131], v216 offset:0
    ds_read_b128 v[132:135], v216 offset:2048
    v_mfma_f32_16x16x32_bf16 v[20:23], v[176:179], v[148:151], v[20:23]
    ds_read_b128 v[136:139], v216 offset:4096
    ds_read_b128 v[140:143], v216 offset:6144
    v_add_u32 v217, s51, v217
    v_mfma_f32_16x16x32_bf16 v[24:27], v[176:179], v[152:155], v[24:27]
    v_add_u32 v218, s51, v218
    ds_read_b64_tr_b16 v[160:161], v218 offset:0
    ds_read_b64_tr_b16 v[162:163], v218 offset:1024
    v_mfma_f32_16x16x32_bf16 v[28:31], v[176:179], v[156:159], v[28:31]
    v_add_u32 v219, s51, v219
    ds_read_b64_tr_b16 v[164:165], v219 offset:0
    ds_read_b64_tr_b16 v[166:167], v219 offset:1024
    v_mfma_f32_16x16x32_bf16 v[32:35], v[180:183], v[144:147], v[32:35]
    v_add_u32 v220, s51, v220
    ds_read_b64_tr_b16 v[168:169], v220 offset:0
    ds_read_b64_tr_b16 v[170:171], v220 offset:1024
    v_mfma_f32_16x16x32_bf16 v[36:39], v[180:183], v[148:151], v[36:39]
    v_add_u32 v221, s51, v221
    ds_read_b64_tr_b16 v[172:173], v221 offset:0
    ds_read_b64_tr_b16 v[174:175], v221 offset:1024
    v_mfma_f32_16x16x32_bf16 v[40:43], v[180:183], v[152:155], v[40:43]
    v_add_u32 v222, s51, v222
    v_add_u32 v223, s51, v223
    v_add_u32 v224, s51, v224
    v_mfma_f32_16x16x32_bf16 v[44:47], v[180:183], v[156:159], v[44:47]
    s_cmp_lt_u32 s40, 8
    v_mfma_f32_16x16x32_bf16 v[48:51], v[184:187], v[144:147], v[48:51]
    v_mfma_f32_16x16x32_bf16 v[52:55], v[184:187], v[148:151], v[52:55]
    v_mfma_f32_16x16x32_bf16 v[56:59], v[184:187], v[152:155], v[56:59]
    v_mfma_f32_16x16x32_bf16 v[60:63], v[184:187], v[156:159], v[60:63]
    v_mfma_f32_16x16x32_bf16 v[64:67], v[188:191], v[144:147], v[64:67]
    v_mfma_f32_16x16x32_bf16 v[68:71], v[188:191], v[148:151], v[68:71]
    v_mfma_f32_16x16x32_bf16 v[72:75], v[188:191], v[152:155], v[72:75]
    v_mfma_f32_16x16x32_bf16 v[76:79], v[188:191], v[156:159], v[76:79]
    s_waitcnt lgkmcnt(0)
    s_cbranch_scc1 K1_loop0
    v_and_b32 v2, 15, v1
    v_lshrrev_b32 v3, 4, v1
    ds_read_b128 v[128:131], v216 offset:0
    ds_read_b128 v[132:135], v216 offset:2048
    ds_read_b128 v[136:139], v216 offset:4096
    ds_read_b128 v[140:143], v216 offset:6144
    ds_read_b64_tr_b16 v[160:161], v222 offset:0
    ds_read_b64_tr_b16 v[162:163], v222 offset:1024
    ds_read_b64_tr_b16 v[164:165], v223 offset:0
    ds_read_b64_tr_b16 v[166:167], v223 offset:1024
    ds_read_b64_tr_b16 v[168:169], v224 offset:0
    ds_read_b64_tr_b16 v[170:171], v224 offset:1024
    s_waitcnt vmcnt(0)
    s_cmp_eq_u32 s19, 14
    s_cbranch_scc1 K1_pure_mid
    s_lshl_b32 s43, s18, 2
    v_mov_b32 v10, s43
    global_load_dword v11, v10, s[12:13] sc1
    v_mov_b32 v226, 0xc0135761
    v_mov_b32 v227, 0xc0135761
    v_mov_b32 v228, 0xbdd2d3e8
    v_mov_b32 v229, 0xbdd2d3e8
    v_mov_b32 v230, 1.0
    v_mov_b32 v231, 1.0
    v_pk_mul_f32 v[192:193], v[16:17], v[16:17]
    v_pk_mul_f32 v[194:195], v[18:19], v[18:19]
    v_pk_mul_f32 v[196:197], v[20:21], v[20:21]
    v_pk_mul_f32 v[198:199], v[22:23], v[22:23]
    v_pk_fma_f32 v[192:193], v[192:193], v[228:229], v[226:227]
    v_pk_fma_f32 v[194:195], v[194:195], v[228:229], v[226:227]
    v_pk_fma_f32 v[196:197], v[196:197], v[228:229], v[226:227]
    v_pk_fma_f32 v[198:199], v[198:199], v[228:229], v[226:227]
    v_pk_mul_f32 v[192:193], v[192:193], v[16:17]
    v_pk_mul_f32 v[194:195], v[194:195], v[18:19]
    v_pk_mul_f32 v[196:197], v[196:197], v[20:21]
    v_pk_mul_f32 v[198:199], v[198:199], v[22:23]
    v_exp_f32 v192, v192
    v_exp_f32 v193, v193
    v_exp_f32 v194, v194
    v_exp_f32 v195, v195
    v_exp_f32 v196, v196
    v_exp_f32 v197, v197
    v_exp_f32 v198, v198
    v_exp_f32 v199, v199
    v_pk_add_f32 v[192:193], v[192:193], v[230:231]
    v_pk_add_f32 v[194:195], v[194:195], v[230:231]
    v_pk_add_f32 v[196:197], v[196:197], v[230:231]
    v_pk_add_f32 v[198:199], v[198:199], v[230:231]
    v_rcp_f32 v192, v192
    v_rcp_f32 v193, v193
    v_rcp_f32 v194, v194
    v_rcp_f32 v195, v195
    v_rcp_f32 v196, v196
    v_rcp_f32 v197, v197
    v_rcp_f32 v198, v198
    v_rcp_f32 v199, v199
    v_pk_mul_f32 v[16:17], v[16:17], v[192:193]
    v_pk_mul_f32 v[18:19], v[18:19], v[194:195]
    v_pk_mul_f32 v[20:21], v[20:21], v[196:197]
    v_pk_mul_f32 v[22:23], v[22:23], v[198:199]
    v_pk_mul_f32 v[192:193], v[24:25], v[24:25]
    v_pk_mul_f32 v[194:195], v[26:27], v[26:27]
    v_pk_mul_f32 v[196:197], v[28:29], v[28:29]
    v_pk_mul_f32 v[198:199], v[30:31], v[30:31]
    v_pk_fma_f32 v[192:193], v[192:193], v[228:229], v[226:227]
    v_pk_fma_f32 v[194:195], v[194:195], v[228:229], v[226:227]
    v_pk_fma_f32 v[196:197], v[196:197], v[228:229], v[226:227]
    v_pk_fma_f32 v[198:199], v[198:199], v[228:229], v[226:227]
    v_pk_mul_f32 v[192:193], v[192:193], v[24:25]
    v_pk_mul_f32 v[194:195], v[194:195], v[26:27]
    v_pk_mul_f32 v[196:197], v[196:197], v[28:29]
    v_pk_mul_f32 v[198:199], v[198:199], v[30:31]
    v_exp_f32 v192, v192
    v_exp_f32 v193, v193
    v_exp_f32 v194, v194
    v_exp_f32 v195, v195
    v_exp_f32 v196, v196
    v_exp_f32 v197, v197
    v_exp_f32 v198, v198
    v_exp_f32 v199, v199
    v_pk_add_f32 v[192:193], v[192:193], v[230:231]
    v_pk_add_f32 v[194:195], v[194:195], v[230:231]
    v_pk_add_f32 v[196:197], v[196:197], v[230:231]
    v_pk_add_f32 v[198:199], v[198:199], v[230:231]
    v_rcp_f32 v192, v192
    v_rcp_f32 v193, v193
    v_rcp_f32 v194, v194
    v_rcp_f32 v195, v195
    v_rcp_f32 v196, v196
    v_rcp_f32 v197, v197
    v_rcp_f32 v198, v198
    v_rcp_f32 v199, v199
    v_pk_mul_f32 v[24:25], v[24:25], v[192:193]
    v_pk_mul_f32 v[26:27], v[26:27], v[194:195]
    v_pk_mul_f32 v[28:29], v[28:29], v[196:197]
    v_pk_mul_f32 v[30:31], v[30:31], v[198:199]
    v_pk_mul_f32 v[192:193], v[32:33], v[32:33]
    v_pk_mul_f32 v[194:195], v[34:35], v[34:35]
    v_pk_mul_f32 v[196:197], v[36:37], v[36:37]
    v_pk_mul_f32 v[198:199], v[38:39], v[38:39]
    v_pk_fma_f32 v[192:193], v[192:193], v[228:229], v[226:227]
    v_pk_fma_f32 v[194:195], v[194:195], v[228:229], v[226:227]
    v_pk_fma_f32 v[196:197], v[196:197], v[228:229], v[226:227]
    v_pk_fma_f32 v[198:199], v[198:199], v[228:229], v[226:227]
    v_pk_mul_f32 v[192:193], v[192:193], v[32:33]
    v_pk_mul_f32 v[194:195], v[194:195], v[34:35]
    v_pk_mul_f32 v[196:197], v[196:197], v[36:37]
    v_pk_mul_f32 v[198:199], v[198:199], v[38:39]
    v_exp_f32 v192, v192
    v_exp_f32 v193, v193
    v_exp_f32 v194, v194
    v_exp_f32 v195, v195
    v_exp_f32 v196, v196
    v_exp_f32 v197, v197
    v_exp_f32 v198, v198
    v_exp_f32 v199, v199
    v_pk_add_f32 v[192:193], v[192:193], v[230:231]
    v_pk_add_f32 v[194:195], v[194:195], v[230:231]
    v_pk_add_f32 v[196:197], v[196:197], v[230:231]
    v_pk_add_f32 v[198:199], v[198:199], v[230:231]
    v_rcp_f32 v192, v192
    v_rcp_f32 v193, v193
    v_rcp_f32 v194, v194
    v_rcp_f32 v195, v195
    v_rcp_f32 v196, v196
    v_rcp_f32 v197, v197
    v_rcp_f32 v198, v198
    v_rcp_f32 v199, v199
    v_pk_mul_f32 v[32:33], v[32:33], v[192:193]
    v_pk_mul_f32 v[34:35], v[34:35], v[194:195]
    v_pk_mul_f32 v[36:37], v[36:37], v[196:197]
    v_pk_mul_f32 v[38:39], v[38:39], v[198:199]
    v_pk_mul_f32 v[192:193], v[40:41], v[40:41]
    v_pk_mul_f32 v[194:195], v[42:43], v[42:43]
    v_pk_mul_f32 v[196:197], v[44:45], v[44:45]
    v_pk_mul_f32 v[198:199], v[46:47], v[46:47]
    v_pk_fma_f32 v[192:193], v[192:193], v[228:229], v[226:227]
    v_pk_fma_f32 v[194:195], v[194:195], v[228:229], v[226:227]
    v_pk_fma_f32 v[196:197], v[196:197], v[228:229], v[226:227]
    v_pk_fma_f32 v[198:199], v[198:199], v[228:229], v[226:227]
    v_pk_mul_f32 v[192:193], v[192:193], v[40:41]
    v_pk_mul_f32 v[194:195], v[194:195], v[42:43]
    v_pk_mul_f32 v[196:197], v[196:197], v[44:45]
    v_pk_mul_f32 v[198:199], v[198:199], v[46:47]
    v_exp_f32 v192, v192
    v_exp_f32 v193, v193
    v_exp_f32 v194, v194
    v_exp_f32 v195, v195
    v_exp_f32 v196, v196
    v_exp_f32 v197, v197
    v_exp_f32 v198, v198
    v_exp_f32 v199, v199
    v_pk_add_f32 v[192:193], v[192:193], v[230:231]
    v_pk_add_f32 v[194:195], v[194:195], v[230:231]
    v_pk_add_f32 v[196:197], v[196:197], v[230:231]
    v_pk_add_f32 v[198:199], v[198:199], v[230:231]
    v_rcp_f32 v192, v192
    v_rcp_f32 v193, v193
    v_rcp_f32 v194, v194
    v_rcp_f32 v195, v195
    v_rcp_f32 v196, v196
    v_rcp_f32 v197, v197
    v_rcp_f32 v198, v198
    v_rcp_f32 v199, v199
    v_pk_mul_f32 v[40:41], v[40:41], v[192:193]
    v_pk_mul_f32 v[42:43], v[42:43], v[194:195]
    v_pk_mul_f32 v[44:45], v[44:45], v[196:197]
    v_pk_mul_f32 v[46:47], v[46:47], v[198:199]
    v_pk_add_f32 v[192:193], v[16:17], v[18:19]
    v_pk_mul_f32 v[194:195], v[16:17], v[16:17]
    v_pk_add_f32 v[196:197], v[32:33], v[34:35]
    v_pk_fma_f32 v[194:195], v[18:19], v[18:19], v[194:195]
    v_pk_add_f32 v[192:193], v[192:193], v[196:197]
    v_pk_fma_f32 v[194:195], v[32:33], v[32:33], v[194:195]
    v_pk_fma_f32 v[194:195], v[34:35], v[34:35], v[194:195]
    v_add_f32 v192, v192, v193
    v_add_f32 v193, v194, v195
    v_pk_add_f32 v[198:199], v[20:21], v[22:23]
    v_pk_mul_f32 v[200:201], v[20:21], v[20:21]
    v_pk_add_f32 v[202:203], v[36:37], v[38:39]
    v_pk_fma_f32 v[200:201], v[22:23], v[22:23], v[200:201]
    v_pk_add_f32 v[198:199], v[198:199], v[202:203]
    v_pk_fma_f32 v[200:201], v[36:37], v[36:37], v[200:201]
    v_pk_fma_f32 v[200:201], v[38:39], v[38:39], v[200:201]
    v_add_f32 v198, v198, v199
    v_add_f32 v199, v200, v201
    v_pk_add_f32 v[204:205], v[24:25], v[26:27]
    v_pk_mul_f32 v[206:207], v[24:25], v[24:25]
    v_pk_add_f32 v[208:209], v[40:41], v[42:43]
    v_pk_fma_f32 v[206:207], v[26:27], v[26:27], v[206:207]
    v_pk_add_f32 v[204:205], v[204:205], v[208:209]
    v_pk_fma_f32 v[206:207], v[40:41], v[40:41], v[206:207]
    v_pk_fma_f32 v[206:207], v[42:43], v[42:43], v[206:207]
    v_add_f32 v204, v204, v205
    v_add_f32 v205, v206, v207
    v_pk_add_f32 v[210:211], v[28:29], v[30:31]
    v_pk_mul_f32 v[212:213], v[28:29], v[28:29]
    v_pk_add_f32 v[214:215], v[44:45], v[46:47]
    v_pk_fma_f32 v[212:213], v[30:31], v[30:31], v[212:213]
    v_pk_add_f32 v[210:211], v[210:211], v[214:215]
    v_pk_fma_f32 v[212:213], v[44:45], v[44:45], v[212:213]
    v_pk_fma_f32 v[212:213], v[46:47], v[46:47], v[212:213]
    v_add_f32 v210, v210, v211
    v_add_f32 v211, v212, v213
    v_permlane32_swap_b32 v192, v204
    v_permlane32_swap_b32 v198, v210
    v_permlane32_swap_b32 v193, v205
    v_permlane32_swap_b32 v199, v211
    v_add_f32 v192, v192, v204
    v_add_f32 v198, v198, v210
    v_add_f32 v193, v193, v205
    v_add_f32 v199, v199, v211
    v_permlane16_swap_b32 v192, v198
    s_nop 0
    v_permlane16_swap_b32 v193, v199
    v_add_f32 v4, v192, v198
    v_add_f32 v5, v193, v199
    v_lshlrev_b32 v6, 4, v1
    s_mov_b32 s88, 0
K1_fchk:
    s_waitcnt vmcnt(0)
    v_readfirstlane_b32 s43, v11
    s_nop 0
    s_cmp_lg_u32 s43, 0
    s_cbranch_scc1 K1_fok
    s_add_u32 s88, s88, 1
    s_cmp_ge_u32 s88, 0x40000
    s_cbranch_scc1 K1_fok
    global_load_dword v11, v10, s[12:13] sc1
    s_branch K1_fchk
K1_fok:
    buffer_store_dwordx2 v[4:5], v6, s[32:35], s62 offen sc1
    s_mov_b32 s62, 6
    s_lshl_b32 s43, s18, 2
    s_lshl_b32 s44, s21, 1
    s_add_u32 s43, s43, s44
    s_mul_i32 s43, s43, 56
    s_lshl_b32 s44, s19, 2
    s_add_u32 s43, s43, s44
    s_lshl_b32 s44, s22, 1
    s_add_u32 s43, s43, s44
    s_lshl_b32 s43, s43, 10
    s_add_u32 s54, s43, 6291456
    v_lshlrev_b32 v5, 4, v1
    v_cvt_pk_bf16_f32 v192, v48, v49
    v_cvt_pk_bf16_f32 v193, v50, v51
    v_cvt_pk_bf16_f32 v194, v52, v53
    v_cvt_pk_bf16_f32 v195, v54, v55
    s_add_u32 s43, s54, 0
    buffer_store_dwordx4 v[192:195], v5, s[32:35], s43 offen offset:0 sc1
    v_cvt_pk_bf16_f32 v196, v64, v65
    v_cvt_pk_bf16_f32 v197, v66, v67
    v_cvt_pk_bf16_f32 v198, v68, v69
    v_cvt_pk_bf16_f32 v199, v70, v71
    buffer_store_dwordx4 v[196:199], v5, s[32:35], s43 offen offset:1024 sc1
    v_cvt_pk_bf16_f32 v200, v56, v57
    v_cvt_pk_bf16_f32 v201, v58, v59
    v_cvt_pk_bf16_f32 v202, v60, v61
    v_cvt_pk_bf16_f32 v203, v62, v63
    s_add_u32 s43, s54, 57344
    buffer_store_dwordx4 v[200:203], v5, s[32:35], s43 offen offset:0 sc1
    v_cvt_pk_bf16_f32 v204, v72, v73
    v_cvt_pk_bf16_f32 v205, v74, v75
    v_cvt_pk_bf16_f32 v206, v76, v77
    v_cvt_pk_bf16_f32 v207, v78, v79
    buffer_store_dwordx4 v[204:207], v5, s[32:35], s43 offen offset:1024 sc1
    s_branch K1_phase1
K1_pure_mid:
    s_mov_b32 s62, 99
    s_mov_b32 s89, 99
    s_lshl_b32 s43, s18, 7
    s_lshl_b32 s44, s21, 6
    s_add_u32 s43, s43, s44
    v_add_u32 v4, s43, v2
    v_lshlrev_b32 v4, 5, v4
    v_lshl_add_u32 v4, v3, 3, v4
    s_lshl_b32 s45, s22, 2
    s_add_u32 s45, s45, 84
    s_cmp_lt_u32 s45, 32
    s_cselect_b32 s44, 0x3eb8aa3b, 1.0
    s_lshl_b32 s43, s45, 16
    v_mov_b32 v8, s44
    v_mov_b32 v9, s44
    v_pk_mul_f32 v[16:17], v[16:17], v[8:9]
    v_pk_mul_f32 v[18:19], v[18:19], v[8:9]
    v_cvt_pk_bf16_f32 v192, v16, v17
    v_cvt_pk_bf16_f32 v193, v18, v19
    buffer_store_dwordx2 v[192:193], v4, s[32:35], s43 offen offset:0
    v_pk_mul_f32 v[20:21], v[20:21], v[8:9]
    v_pk_mul_f32 v[22:23], v[22:23], v[8:9]
    v_cvt_pk_bf16_f32 v194, v20, v21
    v_cvt_pk_bf16_f32 v195, v22, v23
    buffer_store_dwordx2 v[194:195], v4, s[32:35], s43 offen offset:512
    v_pk_mul_f32 v[24:25], v[24:25], v[8:9]
    v_pk_mul_f32 v[26:27], v[26:27], v[8:9]
    v_cvt_pk_bf16_f32 v196, v24, v25
    v_cvt_pk_bf16_f32 v197, v26, v27
    buffer_store_dwordx2 v[196:197], v4, s[32:35], s43 offen offset:1024
    v_pk_mul_f32 v[28:29], v[28:29], v[8:9]
    v_pk_mul_f32 v[30:31], v[30:31], v[8:9]
    v_cvt_pk_bf16_f32 v198, v28, v29
    v_cvt_pk_bf16_f32 v199, v30, v31
    buffer_store_dwordx2 v[198:199], v4, s[32:35], s43 offen offset:1536
    s_lshl_b32 s45, s22, 2
    s_add_u32 s45, s45, 85
    s_cmp_lt_u32 s45, 32
    s_cselect_b32 s44, 0x3eb8aa3b, 1.0
    s_lshl_b32 s43, s45, 16
    v_mov_b32 v8, s44
    v_mov_b32 v9, s44
    v_pk_mul_f32 v[32:33], v[32:33], v[8:9]
    v_pk_mul_f32 v[34:35], v[34:35], v[8:9]
    v_cvt_pk_bf16_f32 v200, v32, v33
    v_cvt_pk_bf16_f32 v201, v34, v35
    buffer_store_dwordx2 v[200:201], v4, s[32:35], s43 offen offset:0
    v_pk_mul_f32 v[36:37], v[36:37], v[8:9]
    v_pk_mul_f32 v[38:39], v[38:39], v[8:9]
    v_cvt_pk_bf16_f32 v202, v36, v37
    v_cvt_pk_bf16_f32 v203, v38, v39
    buffer_store_dwordx2 v[202:203], v4, s[32:35], s43 offen offset:512
    v_pk_mul_f32 v[40:41], v[40:41], v[8:9]
    v_pk_mul_f32 v[42:43], v[42:43], v[8:9]
    v_cvt_pk_bf16_f32 v204, v40, v41
    v_cvt_pk_bf16_f32 v205, v42, v43
    buffer_store_dwordx2 v[204:205], v4, s[32:35], s43 offen offset:1024
    v_pk_mul_f32 v[44:45], v[44:45], v[8:9]
    v_pk_mul_f32 v[46:47], v[46:47], v[8:9]
    v_cvt_pk_bf16_f32 v206, v44, v45
    v_cvt_pk_bf16_f32 v207, v46, v47
    buffer_store_dwordx2 v[206:207], v4, s[32:35], s43 offen offset:1536
    s_lshl_b32 s45, s22, 2
    s_add_u32 s45, s45, 86
    s_cmp_lt_u32 s45, 32
    s_cselect_b32 s44, 0x3eb8aa3b, 1.0
    s_lshl_b32 s43, s45, 16
    v_mov_b32 v8, s44
    v_mov_b32 v9, s44
    v_pk_mul_f32 v[48:49], v[48:49], v[8:9]
    v_pk_mul_f32 v[50:51], v[50:51], v[8:9]
    v_cvt_pk_bf16_f32 v208, v48, v49
    v_cvt_pk_bf16_f32 v209, v50, v51
    buffer_store_dwordx2 v[208:209], v4, s[32:35], s43 offen offset:0
    v_pk_mul_f32 v[52:53], v[52:53], v[8:9]
    v_pk_mul_f32 v[54:55], v[54:55], v[8:9]
    v_cvt_pk_bf16_f32 v210, v52, v53
    v_cvt_pk_bf16_f32 v211, v54, v55
    buffer_store_dwordx2 v[210:211], v4, s[32:35], s43 offen offset:512
    v_pk_mul_f32 v[56:57], v[56:57], v[8:9]
    v_pk_mul_f32 v[58:59], v[58:59], v[8:9]
    v_cvt_pk_bf16_f32 v212, v56, v57
    v_cvt_pk_bf16_f32 v213, v58, v59
    buffer_store_dwordx2 v[212:213], v4, s[32:35], s43 offen offset:1024
    v_pk_mul_f32 v[60:61], v[60:61], v[8:9]
    v_pk_mul_f32 v[62:63], v[62:63], v[8:9]
    v_cvt_pk_bf16_f32 v214, v60, v61
    v_cvt_pk_bf16_f32 v215, v62, v63
    buffer_store_dwordx2 v[214:215], v4, s[32:35], s43 offen offset:1536
    s_lshl_b32 s45, s22, 2
    s_add_u32 s45, s45, 87
    s_cmp_lt_u32 s45, 32
    s_cselect_b32 s44, 0x3eb8aa3b, 1.0
    s_lshl_b32 s43, s45, 16
    v_mov_b32 v8, s44
    v_mov_b32 v9, s44
    v_pk_mul_f32 v[64:65], v[64:65], v[8:9]
    v_pk_mul_f32 v[66:67], v[66:67], v[8:9]
    v_cvt_pk_bf16_f32 v192, v64, v65
    v_cvt_pk_bf16_f32 v193, v66, v67
    buffer_store_dwordx2 v[192:193], v4, s[32:35], s43 offen offset:0
    v_pk_mul_f32 v[68:69], v[68:69], v[8:9]
    v_pk_mul_f32 v[70:71], v[70:71], v[8:9]
    v_cvt_pk_bf16_f32 v194, v68, v69
    v_cvt_pk_bf16_f32 v195, v70, v71
    buffer_store_dwordx2 v[194:195], v4, s[32:35], s43 offen offset:512
    v_pk_mul_f32 v[72:73], v[72:73], v[8:9]
    v_pk_mul_f32 v[74:75], v[74:75], v[8:9]
    v_cvt_pk_bf16_f32 v196, v72, v73
    v_cvt_pk_bf16_f32 v197, v74, v75
    buffer_store_dwordx2 v[196:197], v4, s[32:35], s43 offen offset:1024
    v_pk_mul_f32 v[76:77], v[76:77], v[8:9]
    v_pk_mul_f32 v[78:79], v[78:79], v[8:9]
    v_cvt_pk_bf16_f32 v198, v76, v77
    v_cvt_pk_bf16_f32 v199, v78, v79
    buffer_store_dwordx2 v[198:199], v4, s[32:35], s43 offen offset:1536
K1_phase1:
    s_mov_b32 s40, 0
    s_waitcnt lgkmcnt(0)
.p2align 6
K1_loop1:
    s_cmp_eq_u32 s40, s62
    s_cbranch_scc1 K1_zfin
K1_zback:
    v_mfma_f32_16x16x32_bf16 v[80:83], v[160:163], v[128:131], v[80:83]
    ds_read_b128 v[144:147], v217 offset:0
    ds_read_b128 v[148:151], v217 offset:2048
    v_mfma_f32_16x16x32_bf16 v[84:87], v[160:163], v[132:135], v[84:87]
    ds_read_b128 v[152:155], v217 offset:4096
    ds_read_b128 v[156:159], v217 offset:6144
    v_mfma_f32_16x16x32_bf16 v[88:91], v[160:163], v[136:139], v[88:91]
    ds_read_b64_tr_b16 v[176:177], v222 offset:8192
    ds_read_b64_tr_b16 v[178:179], v222 offset:9216
    v_mfma_f32_16x16x32_bf16 v[92:95], v[160:163], v[140:143], v[92:95]
    ds_read_b64_tr_b16 v[180:181], v223 offset:8192
    ds_read_b64_tr_b16 v[182:183], v223 offset:9216
    v_mfma_f32_16x16x32_bf16 v[96:99], v[164:167], v[128:131], v[96:99]
    ds_read_b64_tr_b16 v[184:185], v224 offset:8192
    ds_read_b64_tr_b16 v[186:187], v224 offset:9216
    v_mfma_f32_16x16x32_bf16 v[100:103], v[164:167], v[132:135], v[100:103]
    s_cmp_eq_u32 s41, 3
    s_mov_b32 s51, 32768
    v_mfma_f32_16x16x32_bf16 v[104:107], v[164:167], v[136:139], v[104:107]
    s_cselect_b32 s51, 4294868992, s51
    s_add_u32 s41, s41, 1
    v_mfma_f32_16x16x32_bf16 v[108:111], v[164:167], v[140:143], v[108:111]
    s_and_b32 s41, s41, 3
    s_add_u32 s40, s40, 1
    v_mfma_f32_16x16x32_bf16 v[112:115], v[168:171], v[128:131], v[112:115]
    v_mfma_f32_16x16x32_bf16 v[116:119], v[168:171], v[132:135], v[116:119]
    v_mfma_f32_16x16x32_bf16 v[120:123], v[168:171], v[136:139], v[120:123]
    v_mfma_f32_16x16x32_bf16 v[124:127], v[168:171], v[140:143], v[124:127]
    s_waitcnt lgkmcnt(0)
    s_barrier
    v_mfma_f32_16x16x32_bf16 v[80:83], v[176:179], v[144:147], v[80:83]
    v_add_u32 v216, s51, v216
    ds_read_b128 v[128:131], v216 offset:0
    ds_read_b128 v[132:135], v216 offset:2048
    v_mfma_f32_16x16x32_bf16 v[84:87], v[176:179], v[148:151], v[84:87]
    ds_read_b128 v[136:139], v216 offset:4096
    ds_read_b128 v[140:143], v216 offset:6144
    v_add_u32 v217, s51, v217
    v_mfma_f32_16x16x32_bf16 v[88:91], v[176:179], v[152:155], v[88:91]
    v_add_u32 v222, s51, v222
    ds_read_b64_tr_b16 v[160:161], v222 offset:0
    ds_read_b64_tr_b16 v[162:163], v222 offset:1024
    v_mfma_f32_16x16x32_bf16 v[92:95], v[176:179], v[156:159], v[92:95]
    v_add_u32 v223, s51, v223
    ds_read_b64_tr_b16 v[164:165], v223 offset:0
    ds_read_b64_tr_b16 v[166:167], v223 offset:1024
    v_mfma_f32_16x16x32_bf16 v[96:99], v[180:183], v[144:147], v[96:99]
    v_add_u32 v224, s51, v224
    ds_read_b64_tr_b16 v[168:169], v224 offset:0
    ds_read_b64_tr_b16 v[170:171], v224 offset:1024
    v_mfma_f32_16x16x32_bf16 v[100:103], v[180:183], v[148:151], v[100:103]
    v_add_u32 v218, s51, v218
    v_add_u32 v219, s51, v219
    v_add_u32 v220, s51, v220
    v_mfma_f32_16x16x32_bf16 v[104:107], v[180:183], v[152:155], v[104:107]
    v_add_u32 v221, s51, v221
    s_cmp_lt_u32 s40, 8
    v_mfma_f32_16x16x32_bf16 v[108:111], v[180:183], v[156:159], v[108:111]
    v_mfma_f32_16x16x32_bf16 v[112:115], v[184:187], v[144:147], v[112:115]
    v_mfma_f32_16x16x32_bf16 v[116:119], v[184:187], v[148:151], v[116:119]
    v_mfma_f32_16x16x32_bf16 v[120:123], v[184:187], v[152:155], v[120:123]
    v_mfma_f32_16x16x32_bf16 v[124:127], v[184:187], v[156:159], v[124:127]
    s_waitcnt lgkmcnt(0)
    s_cbranch_scc1 K1_loop1
    v_and_b32 v2, 15, v1
    v_lshrrev_b32 v3, 4, v1
    s_lshl_b32 s43, s18, 7
    s_lshl_b32 s44, s21, 6
    s_add_u32 s43, s43, s44
    v_add_u32 v4, s43, v2
    v_lshlrev_b32 v4, 5, v4
    v_lshl_add_u32 v4, v3, 3, v4
    s_cmp_eq_u32 s19, 14
    s_cbranch_scc1 K1_pure_tail
    s_mul_i32 s55, s19, 6
    s_mul_i32 s44, s22, 3
    s_add_u32 s55, s55, s44
    s_add_u32 s45, s55, 0
    s_cmp_lt_u32 s45, 32
    s_cselect_b32 s44, 0x3eb8aa3b, 1.0
    s_lshl_b32 s43, s45, 16
    v_mov_b32 v8, s44
    v_mov_b32 v9, s44
    v_pk_mul_f32 v[80:81], v[80:81], v[8:9]
    v_pk_mul_f32 v[82:83], v[82:83], v[8:9]
    v_cvt_pk_bf16_f32 v160, v80, v81
    v_cvt_pk_bf16_f32 v161, v82, v83
    buffer_store_dwordx2 v[160:161], v4, s[32:35], s43 offen offset:0
    v_pk_mul_f32 v[84:85], v[84:85], v[8:9]
    v_pk_mul_f32 v[86:87], v[86:87], v[8:9]
    v_cvt_pk_bf16_f32 v162, v84, v85
    v_cvt_pk_bf16_f32 v163, v86, v87
    buffer_store_dwordx2 v[162:163], v4, s[32:35], s43 offen offset:512
    v_pk_mul_f32 v[88:89], v[88:89], v[8:9]
    v_pk_mul_f32 v[90:91], v[90:91], v[8:9]
    v_cvt_pk_bf16_f32 v164, v88, v89
    v_cvt_pk_bf16_f32 v165, v90, v91
    buffer_store_dwordx2 v[164:165], v4, s[32:35], s43 offen offset:1024
    v_pk_mul_f32 v[92:93], v[92:93], v[8:9]
    v_pk_mul_f32 v[94:95], v[94:95], v[8:9]
    v_cvt_pk_bf16_f32 v166, v92, v93
    v_cvt_pk_bf16_f32 v167, v94, v95
    buffer_store_dwordx2 v[166:167], v4, s[32:35], s43 offen offset:1536
    s_add_u32 s45, s55, 1
    s_cmp_lt_u32 s45, 32
    s_cselect_b32 s44, 0x3eb8aa3b, 1.0
    s_lshl_b32 s43, s45, 16
    v_mov_b32 v8, s44
    v_mov_b32 v9, s44
    v_pk_mul_f32 v[96:97], v[96:97], v[8:9]
    v_pk_mul_f32 v[98:99], v[98:99], v[8:9]
    v_cvt_pk_bf16_f32 v168, v96, v97
    v_cvt_pk_bf16_f32 v169, v98, v99
    buffer_store_dwordx2 v[168:169], v4, s[32:35], s43 offen offset:0
    v_pk_mul_f32 v[100:101], v[100:101], v[8:9]
    v_pk_mul_f32 v[102:103], v[102:103], v[8:9]
    v_cvt_pk_bf16_f32 v170, v100, v101
    v_cvt_pk_bf16_f32 v171, v102, v103
    buffer_store_dwordx2 v[170:171], v4, s[32:35], s43 offen offset:512
    v_pk_mul_f32 v[104:105], v[104:105], v[8:9]
    v_pk_mul_f32 v[106:107], v[106:107], v[8:9]
    v_cvt_pk_bf16_f32 v172, v104, v105
    v_cvt_pk_bf16_f32 v173, v106, v107
    buffer_store_dwordx2 v[172:173], v4, s[32:35], s43 offen offset:1024
    v_pk_mul_f32 v[108:109], v[108:109], v[8:9]
    v_pk_mul_f32 v[110:111], v[110:111], v[8:9]
    v_cvt_pk_bf16_f32 v174, v108, v109
    v_cvt_pk_bf16_f32 v175, v110, v111
    buffer_store_dwordx2 v[174:175], v4, s[32:35], s43 offen offset:1536
    s_add_u32 s45, s55, 2
    s_cmp_lt_u32 s45, 32
    s_cselect_b32 s44, 0x3eb8aa3b, 1.0
    s_lshl_b32 s43, s45, 16
    v_mov_b32 v8, s44
    v_mov_b32 v9, s44
    v_pk_mul_f32 v[112:113], v[112:113], v[8:9]
    v_pk_mul_f32 v[114:115], v[114:115], v[8:9]
    v_cvt_pk_bf16_f32 v176, v112, v113
    v_cvt_pk_bf16_f32 v177, v114, v115
    buffer_store_dwordx2 v[176:177], v4, s[32:35], s43 offen offset:0
    v_pk_mul_f32 v[116:117], v[116:117], v[8:9]
    v_pk_mul_f32 v[118:119], v[118:119], v[8:9]
    v_cvt_pk_bf16_f32 v178, v116, v117
    v_cvt_pk_bf16_f32 v179, v118, v119
    buffer_store_dwordx2 v[178:179], v4, s[32:35], s43 offen offset:512
    v_pk_mul_f32 v[120:121], v[120:121], v[8:9]
    v_pk_mul_f32 v[122:123], v[122:123], v[8:9]
    v_cvt_pk_bf16_f32 v180, v120, v121
    v_cvt_pk_bf16_f32 v181, v122, v123
    buffer_store_dwordx2 v[180:181], v4, s[32:35], s43 offen offset:1024
    v_pk_mul_f32 v[124:125], v[124:125], v[8:9]
    v_pk_mul_f32 v[126:127], v[126:127], v[8:9]
    v_cvt_pk_bf16_f32 v182, v124, v125
    v_cvt_pk_bf16_f32 v183, v126, v127
    buffer_store_dwordx2 v[182:183], v4, s[32:35], s43 offen offset:1536
    s_branch K1_fin
K1_zfin:
    v_and_b32 v2, 15, v1
    v_lshrrev_b32 v3, 4, v1
    s_lshl_b32 s43, s21, 6
    v_add_u32 v6, s43, v2
    v_lshlrev_b32 v6, 3, v6
    v_add_u32 v6, 131072, v6
    ds_read_b64 v[232:233], v6 offset:0
    ds_read_b64 v[234:235], v6 offset:128
    ds_read_b64 v[236:237], v6 offset:256
    ds_read_b64 v[238:239], v6 offset:384
    s_lshl_b32 s47, s20, 12
    s_add_u32 s47, s47, 132096
    v_lshlrev_b32 v6, 5, v2
    v_lshl_add_u32 v6, v3, 3, v6
    v_add_u32 v6, s47, v6
    s_waitcnt lgkmcnt(0)
    v_fma_f32 v16, v16, v233, v232
    v_fma_f32 v17, v17, v233, v232
    v_fma_f32 v18, v18, v233, v232
    v_fma_f32 v19, v19, v233, v232
    v_cvt_pk_bf16_f32 v192, v16, v17
    v_cvt_pk_bf16_f32 v193, v18, v19
    ds_write_b64 v6, v[192:193] offset:0
    v_fma_f32 v20, v20, v235, v234
    v_fma_f32 v21, v21, v235, v234
    v_fma_f32 v22, v22, v235, v234
    v_fma_f32 v23, v23, v235, v234
    v_cvt_pk_bf16_f32 v194, v20, v21
    v_cvt_pk_bf16_f32 v195, v22, v23
    ds_write_b64 v6, v[194:195] offset:512
    v_fma_f32 v24, v24, v237, v236
    v_fma_f32 v25, v25, v237, v236
    v_fma_f32 v26, v26, v237, v236
    v_fma_f32 v27, v27, v237, v236
    v_cvt_pk_bf16_f32 v196, v24, v25
    v_cvt_pk_bf16_f32 v197, v26, v27
    ds_write_b64 v6, v[196:197] offset:1024
    v_fma_f32 v28, v28, v239, v238
    v_fma_f32 v29, v29, v239, v238
    v_fma_f32 v30, v30, v239, v238
    v_fma_f32 v31, v31, v239, v238
    v_cvt_pk_bf16_f32 v198, v28, v29
    v_cvt_pk_bf16_f32 v199, v30, v31
    ds_write_b64 v6, v[198:199] offset:1536
    v_fma_f32 v32, v32, v233, v232
    v_fma_f32 v33, v33, v233, v232
    v_fma_f32 v34, v34, v233, v232
    v_fma_f32 v35, v35, v233, v232
    v_cvt_pk_bf16_f32 v200, v32, v33
    v_cvt_pk_bf16_f32 v201, v34, v35
    ds_write_b64 v6, v[200:201] offset:2048
    v_fma_f32 v36, v36, v235, v234
    v_fma_f32 v37, v37, v235, v234
    v_fma_f32 v38, v38, v235, v234
    v_fma_f32 v39, v39, v235, v234
    v_cvt_pk_bf16_f32 v202, v36, v37
    v_cvt_pk_bf16_f32 v203, v38, v39
    ds_write_b64 v6, v[202:203] offset:2560
    v_fma_f32 v40, v40, v237, v236
    v_fma_f32 v41, v41, v237, v236
    v_fma_f32 v42, v42, v237, v236
    v_fma_f32 v43, v43, v237, v236
    v_cvt_pk_bf16_f32 v204, v40, v41
    v_cvt_pk_bf16_f32 v205, v42, v43
    ds_write_b64 v6, v[204:205] offset:3072
    v_fma_f32 v44, v44, v239, v238
    v_fma_f32 v45, v45, v239, v238
    v_fma_f32 v46, v46, v239, v238
    v_fma_f32 v47, v47, v239, v238
    v_cvt_pk_bf16_f32 v206, v44, v45
    v_cvt_pk_bf16_f32 v207, v46, v47
    ds_write_b64 v6, v[206:207] offset:3584
    v_lshlrev_b32 v6, 3, v2
    v_lshl_add_u32 v6, v3, 8, v6
    v_add_u32 v6, s47, v6
    s_lshl_b32 s43, s19, 2
    s_lshl_b32 s44, s22, 1
    s_add_u32 s43, s43, s44
    s_lshl_b32 s43, s43, 16
    s_lshl_b32 s44, s18, 2
    s_lshl_b32 s45, s21, 1
    s_add_u32 s44, s44, s45
    s_lshl_b32 s44, s44, 10
    s_add_u32 s43, s43, s44
    s_add_u32 s46, s43, 10485760
    s_add_u32 s47, s46, 65536
    v_lshlrev_b32 v7, 4, v1
    s_waitcnt lgkmcnt(0)
    ds_read_b64_tr_b16 v[240:241], v6 offset:0
    ds_read_b64_tr_b16 v[242:243], v6 offset:128
    ds_read_b64_tr_b16 v[244:245], v6 offset:1024
    ds_read_b64_tr_b16 v[246:247], v6 offset:1152
    ds_read_b64_tr_b16 v[248:249], v6 offset:2048
    ds_read_b64_tr_b16 v[250:251], v6 offset:2176
    ds_read_b64_tr_b16 v[252:253], v6 offset:3072
    ds_read_b64_tr_b16 v[254:255], v6 offset:3200
    s_waitcnt lgkmcnt(6)
    buffer_store_dwordx4 v[240:243], v7, s[32:35], s46 offen offset:0 sc1
    s_waitcnt lgkmcnt(4)
    buffer_store_dwordx4 v[244:247], v7, s[32:35], s46 offen offset:1024 sc1
    s_waitcnt lgkmcnt(2)
    buffer_store_dwordx4 v[248:251], v7, s[32:35], s47 offen offset:0 sc1
    s_waitcnt lgkmcnt(0)
    buffer_store_dwordx4 v[252:255], v7, s[32:35], s47 offen offset:1024 sc1
    s_mov_b32 s62, 99
    s_branch K1_zback
K1_pure_tail:
    s_lshl_b32 s45, s22, 1
    s_add_u32 s45, s45, 92
    s_cmp_lt_u32 s45, 32
    s_cselect_b32 s44, 0x3eb8aa3b, 1.0
    s_lshl_b32 s43, s45, 16
    v_mov_b32 v8, s44
    v_mov_b32 v9, s44
    v_pk_mul_f32 v[80:81], v[80:81], v[8:9]
    v_pk_mul_f32 v[82:83], v[82:83], v[8:9]
    v_cvt_pk_bf16_f32 v160, v80, v81
    v_cvt_pk_bf16_f32 v161, v82, v83
    buffer_store_dwordx2 v[160:161], v4, s[32:35], s43 offen offset:0
    v_pk_mul_f32 v[84:85], v[84:85], v[8:9]
    v_pk_mul_f32 v[86:87], v[86:87], v[8:9]
    v_cvt_pk_bf16_f32 v162, v84, v85
    v_cvt_pk_bf16_f32 v163, v86, v87
    buffer_store_dwordx2 v[162:163], v4, s[32:35], s43 offen offset:512
    v_pk_mul_f32 v[88:89], v[88:89], v[8:9]
    v_pk_mul_f32 v[90:91], v[90:91], v[8:9]
    v_cvt_pk_bf16_f32 v164, v88, v89
    v_cvt_pk_bf16_f32 v165, v90, v91
    buffer_store_dwordx2 v[164:165], v4, s[32:35], s43 offen offset:1024
    v_pk_mul_f32 v[92:93], v[92:93], v[8:9]
    v_pk_mul_f32 v[94:95], v[94:95], v[8:9]
    v_cvt_pk_bf16_f32 v166, v92, v93
    v_cvt_pk_bf16_f32 v167, v94, v95
    buffer_store_dwordx2 v[166:167], v4, s[32:35], s43 offen offset:1536
    s_lshl_b32 s45, s22, 1
    s_add_u32 s45, s45, 93
    s_cmp_lt_u32 s45, 32
    s_cselect_b32 s44, 0x3eb8aa3b, 1.0
    s_lshl_b32 s43, s45, 16
    v_mov_b32 v8, s44
    v_mov_b32 v9, s44
    v_pk_mul_f32 v[96:97], v[96:97], v[8:9]
    v_pk_mul_f32 v[98:99], v[98:99], v[8:9]
    v_cvt_pk_bf16_f32 v168, v96, v97
    v_cvt_pk_bf16_f32 v169, v98, v99
    buffer_store_dwordx2 v[168:169], v4, s[32:35], s43 offen offset:0
    v_pk_mul_f32 v[100:101], v[100:101], v[8:9]
    v_pk_mul_f32 v[102:103], v[102:103], v[8:9]
    v_cvt_pk_bf16_f32 v170, v100, v101
    v_cvt_pk_bf16_f32 v171, v102, v103
    buffer_store_dwordx2 v[170:171], v4, s[32:35], s43 offen offset:512
    v_pk_mul_f32 v[104:105], v[104:105], v[8:9]
    v_pk_mul_f32 v[106:107], v[106:107], v[8:9]
    v_cvt_pk_bf16_f32 v172, v104, v105
    v_cvt_pk_bf16_f32 v173, v106, v107
    buffer_store_dwordx2 v[172:173], v4, s[32:35], s43 offen offset:1024
    v_pk_mul_f32 v[108:109], v[108:109], v[8:9]
    v_pk_mul_f32 v[110:111], v[110:111], v[8:9]
    v_cvt_pk_bf16_f32 v174, v108, v109
    v_cvt_pk_bf16_f32 v175, v110, v111
    buffer_store_dwordx2 v[174:175], v4, s[32:35], s43 offen offset:1536
    s_branch K1_fin
K1_spare:
    s_waitcnt lgkmcnt(0)
    s_mov_b32 s32, s14
    s_mov_b32 s33, s15
    s_mov_b32 s34, 22020096
    s_mov_b32 s35, 0x20000
    s_mul_i32 s43, s18, 28672
    s_lshl_b32 s44, s20, 10
    s_add_u32 s43, s43, s44
    s_add_u32 s43, s43, 20971520
    v_lshlrev_b32 v2, 4, v1
    v_mov_b32 v4, -1
    v_mov_b32 v5, -1
    v_mov_b32 v6, -1
    v_mov_b32 v7, -1
    buffer_store_dwordx4 v[4:7], v2, s[32:35], s43 offen sc1
    s_add_u32 s43, s43, 8192
    buffer_store_dwordx4 v[4:7], v2, s[32:35], s43 offen sc1
    s_add_u32 s43, s43, 8192
    buffer_store_dwordx4 v[4:7], v2, s[32:35], s43 offen sc1
    s_add_u32 s43, s43, 8192
    s_cmp_lt_u32 s20, 4
    s_cbranch_scc0 K1_rs3
    buffer_store_dwordx4 v[4:7], v2, s[32:35], s43 offen sc1
K1_rs3:
    s_cmp_eq_u32 s18, 0
    s_cbranch_scc0 K1_zf
    s_cmp_ge_u32 s20, 5
    s_cbranch_scc0 K1_zf
    s_sub_u32 s43, s20, 5
    s_lshl_b32 s43, s43, 10
    s_add_u32 s43, s43, 21561344
    v_mov_b32 v4, 0
    v_mov_b32 v5, 0
    v_mov_b32 v6, 0
    v_mov_b32 v7, 0
    buffer_store_dwordx4 v[4:7], v2, s[32:35], s43 offen sc1
K1_zf:
    s_waitcnt vmcnt(0)
    s_barrier
    s_cmp_eq_u32 s20, 0
    s_cbranch_scc0 K1_rs4
    s_lshl_b32 s43, s18, 2
    v_mov_b32 v2, s43
    v_mov_b32 v3, 1
    s_mov_b64 s[52:53], exec
    s_mov_b64 exec, 1
    global_store_dword v2, v3, s[12:13] sc1
    s_mov_b64 exec, s[52:53]
K1_rs4:
    s_and_b32 s43, s17, 1
    s_lshl_b32 s43, s43, 3
    s_add_u32 s43, s43, s20
    s_getpc_b64 s[92:93]
PC_k1:
    s_mov_b32 s94, gm_k1_kernel-PC_k1
    s_ashr_i32 s95, s94, 31
    s_add_u32 s92, s92, s94
    s_addc_u32 s93, s93, s95
    s_mov_b32 s94, gm_code_end-gm_k1_kernel
    s_mov_b32 s95, 0x20000
    s_mul_i32 s91, s43, 3072
    v_lshlrev_b32 v200, 4, v1
    buffer_load_dwordx4 v[204:207], v200, s[92:95], s91 offen offset:0
    buffer_load_dwordx4 v[208:211], v200, s[92:95], s91 offen offset:1024
    buffer_load_dwordx4 v[212:215], v200, s[92:95], s91 offen offset:2048
    s_lshl_b32 s18, s18, 7
    s_lshl_b32 s43, s20, 4
    s_add_u32 s18, s18, s43
    s_mov_b32 s24, s4
    s_mov_b32 s25, s5
    s_mov_b32 s26, 2097152
    s_mov_b32 s27, 0x20000
    s_mov_b32 s28, s58
    s_mov_b32 s29, s59
    s_mov_b32 s30, 1024
    s_mov_b32 s31, 0x20000
    s_mov_b32 s32, s14
    s_mov_b32 s33, s15
    s_mov_b32 s34, 22020096
    s_mov_b32 s35, 0x20000
    v_and_b32 v2, 15, v1
    v_lshrrev_b32 v3, 4, v1
    v_lshlrev_b32 v4, 4, v2
    buffer_load_dwordx4 v[16:19], v4, s[28:31], 0 offen offset:0
    buffer_load_dwordx4 v[20:23], v4, s[28:31], 0 offen offset:256
    buffer_load_dwordx4 v[24:27], v4, s[28:31], 0 offen offset:512
    buffer_load_dwordx4 v[28:31], v4, s[28:31], 0 offen offset:768
    v_add_u32 v5, s18, v3
    v_lshl_add_u32 v5, v5, 10, v4
    buffer_load_dwordx4 v[64:67], v5, s[24:27], 0 offen offset:0
    buffer_load_dwordx4 v[68:71], v5, s[24:27], 0 offen offset:256
    buffer_load_dwordx4 v[72:75], v5, s[24:27], 0 offen offset:512
    buffer_load_dwordx4 v[76:79], v5, s[24:27], 0 offen offset:768
    v_add_u32 v5, 4096, v5
    buffer_load_dwordx4 v[80:83], v5, s[24:27], 0 offen offset:0
    buffer_load_dwordx4 v[84:87], v5, s[24:27], 0 offen offset:256
    buffer_load_dwordx4 v[88:91], v5, s[24:27], 0 offen offset:512
    buffer_load_dwordx4 v[92:95], v5, s[24:27], 0 offen offset:768
    v_add_u32 v5, 4096, v5
    buffer_load_dwordx4 v[96:99], v5, s[24:27], 0 offen offset:0
    buffer_load_dwordx4 v[100:103], v5, s[24:27], 0 offen offset:256
    buffer_load_dwordx4 v[104:107], v5, s[24:27], 0 offen offset:512
    buffer_load_dwordx4 v[108:111], v5, s[24:27], 0 offen offset:768
    v_add_u32 v5, 4096, v5
    buffer_load_dwordx4 v[112:115], v5, s[24:27], 0 offen offset:0
    buffer_load_dwordx4 v[116:119], v5, s[24:27], 0 offen offset:256
    buffer_load_dwordx4 v[120:123], v5, s[24:27], 0 offen offset:512
    buffer_load_dwordx4 v[124:127], v5, s[24:27], 0 offen offset:768
    v_add_u32 v5, 4096, v5
    v_add_u32 v6, s18, v3
    v_lshlrev_b32 v6, 2, v6
    s_waitcnt vmcnt(12)
    v_dot2_f32_bf16 v8, v64, v16, 0
    v_dot2_f32_bf16 v8, v65, v17, v8
    v_dot2_f32_bf16 v8, v66, v18, v8
    v_dot2_f32_bf16 v8, v67, v19, v8
    v_dot2_f32_bf16 v8, v68, v20, v8
    v_dot2_f32_bf16 v8, v69, v21, v8
    v_dot2_f32_bf16 v8, v70, v22, v8
    v_dot2_f32_bf16 v8, v71, v23, v8
    v_dot2_f32_bf16 v8, v72, v24, v8
    v_dot2_f32_bf16 v8, v73, v25, v8
    v_dot2_f32_bf16 v8, v74, v26, v8
    v_dot2_f32_bf16 v8, v75, v27, v8
    v_dot2_f32_bf16 v8, v76, v28, v8
    v_dot2_f32_bf16 v8, v77, v29, v8
    v_dot2_f32_bf16 v8, v78, v30, v8
    v_dot2_f32_bf16 v8, v79, v31, v8
    s_nop 2
    v_add_f32_dpp v8, v8, v8 row_shr:8 row_mask:0xf bank_mask:0xf bound_ctrl:1
    s_nop 1
    v_add_f32_dpp v8, v8, v8 row_shr:4 row_mask:0xf bank_mask:0xf bound_ctrl:1
    s_nop 1
    v_add_f32_dpp v8, v8, v8 row_shr:2 row_mask:0xf bank_mask:0xf bound_ctrl:1
    s_nop 1
    v_add_f32_dpp v8, v8, v8 row_shr:1 row_mask:0xf bank_mask:0xf bound_ctrl:1
    v_mul_f32 v8, 0xbfb8aa3b, v8
    v_exp_f32 v8, v8
    s_nop 0
    v_add_f32 v8, 1.0, v8
    v_rcp_f32 v8, v8
    s_nop 0
    v_mov_b32 v32, v8
    s_waitcnt vmcnt(8)
    v_dot2_f32_bf16 v8, v80, v16, 0
    v_dot2_f32_bf16 v8, v81, v17, v8
    v_dot2_f32_bf16 v8, v82, v18, v8
    v_dot2_f32_bf16 v8, v83, v19, v8
    v_dot2_f32_bf16 v8, v84, v20, v8
    v_dot2_f32_bf16 v8, v85, v21, v8
    v_dot2_f32_bf16 v8, v86, v22, v8
    v_dot2_f32_bf16 v8, v87, v23, v8
    v_dot2_f32_bf16 v8, v88, v24, v8
    v_dot2_f32_bf16 v8, v89, v25, v8
    v_dot2_f32_bf16 v8, v90, v26, v8
    v_dot2_f32_bf16 v8, v91, v27, v8
    v_dot2_f32_bf16 v8, v92, v28, v8
    v_dot2_f32_bf16 v8, v93, v29, v8
    v_dot2_f32_bf16 v8, v94, v30, v8
    v_dot2_f32_bf16 v8, v95, v31, v8
    s_nop 2
    v_add_f32_dpp v8, v8, v8 row_shr:8 row_mask:0xf bank_mask:0xf bound_ctrl:1
    s_nop 1
    v_add_f32_dpp v8, v8, v8 row_shr:4 row_mask:0xf bank_mask:0xf bound_ctrl:1
    s_nop 1
    v_add_f32_dpp v8, v8, v8 row_shr:2 row_mask:0xf bank_mask:0xf bound_ctrl:1
    s_nop 1
    v_add_f32_dpp v8, v8, v8 row_shr:1 row_mask:0xf bank_mask:0xf bound_ctrl:1
    v_mul_f32 v8, 0xbfb8aa3b, v8
    v_exp_f32 v8, v8
    s_nop 0
    v_add_f32 v8, 1.0, v8
    v_rcp_f32 v8, v8
    s_nop 0
    v_mov_b32 v33, v8
    s_waitcnt vmcnt(4)
    v_dot2_f32_bf16 v8, v96, v16, 0
    v_dot2_f32_bf16 v8, v97, v17, v8
    v_dot2_f32_bf16 v8, v98, v18, v8
    v_dot2_f32_bf16 v8, v99, v19, v8
    v_dot2_f32_bf16 v8, v100, v20, v8
    v_dot2_f32_bf16 v8, v101, v21, v8
    v_dot2_f32_bf16 v8, v102, v22, v8
    v_dot2_f32_bf16 v8, v103, v23, v8
    v_dot2_f32_bf16 v8, v104, v24, v8
    v_dot2_f32_bf16 v8, v105, v25, v8
    v_dot2_f32_bf16 v8, v106, v26, v8
    v_dot2_f32_bf16 v8, v107, v27, v8
    v_dot2_f32_bf16 v8, v108, v28, v8
    v_dot2_f32_bf16 v8, v109, v29, v8
    v_dot2_f32_bf16 v8, v110, v30, v8
    v_dot2_f32_bf16 v8, v111, v31, v8
    s_nop 2
    v_add_f32_dpp v8, v8, v8 row_shr:8 row_mask:0xf bank_mask:0xf bound_ctrl:1
    s_nop 1
    v_add_f32_dpp v8, v8, v8 row_shr:4 row_mask:0xf bank_mask:0xf bound_ctrl:1
    s_nop 1
    v_add_f32_dpp v8, v8, v8 row_shr:2 row_mask:0xf bank_mask:0xf bound_ctrl:1
    s_nop 1
    v_add_f32_dpp v8, v8, v8 row_shr:1 row_mask:0xf bank_mask:0xf bound_ctrl:1
    v_mul_f32 v8, 0xbfb8aa3b, v8
    v_exp_f32 v8, v8
    s_nop 0
    v_add_f32 v8, 1.0, v8
    v_rcp_f32 v8, v8
    s_nop 0
    v_mov_b32 v34, v8
    s_waitcnt vmcnt(0)
    v_dot2_f32_bf16 v8, v112, v16, 0
    v_dot2_f32_bf16 v8, v113, v17, v8
    v_dot2_f32_bf16 v8, v114, v18, v8
    v_dot2_f32_bf16 v8, v115, v19, v8
    v_dot2_f32_bf16 v8, v116, v20, v8
    v_dot2_f32_bf16 v8, v117, v21, v8
    v_dot2_f32_bf16 v8, v118, v22, v8
    v_dot2_f32_bf16 v8, v119, v23, v8
    v_dot2_f32_bf16 v8, v120, v24, v8
    v_dot2_f32_bf16 v8, v121, v25, v8
    v_dot2_f32_bf16 v8, v122, v26, v8
    v_dot2_f32_bf16 v8, v123, v27, v8
    v_dot2_f32_bf16 v8, v124, v28, v8
    v_dot2_f32_bf16 v8, v125, v29, v8
    v_dot2_f32_bf16 v8, v126, v30, v8
    v_dot2_f32_bf16 v8, v127, v31, v8
    s_nop 2
    v_add_f32_dpp v8, v8, v8 row_shr:8 row_mask:0xf bank_mask:0xf bound_ctrl:1
    s_nop 1
    v_add_f32_dpp v8, v8, v8 row_shr:4 row_mask:0xf bank_mask:0xf bound_ctrl:1
    s_nop 1
    v_add_f32_dpp v8, v8, v8 row_shr:2 row_mask:0xf bank_mask:0xf bound_ctrl:1
    s_nop 1
    v_add_f32_dpp v8, v8, v8 row_shr:1 row_mask:0xf bank_mask:0xf bound_ctrl:1
    v_mul_f32 v8, 0xbfb8aa3b, v8
    v_exp_f32 v8, v8
    s_nop 0
    v_add_f32 v8, 1.0, v8
    v_rcp_f32 v8, v8
    s_nop 0
    v_mov_b32 v35, v8
    v_cmp_eq_u32 s[52:53], 15, v2
    s_mov_b64 s[54:55], exec
    s_and_b64 exec, exec, s[52:53]
    s_mov_b32 s51, 21495808
    buffer_store_dword v32, v6, s[32:35], s51 offen offset:0
    buffer_store_dword v33, v6, s[32:35], s51 offen offset:16
    buffer_store_dword v34, v6, s[32:35], s51 offen offset:32
    buffer_store_dword v35, v6, s[32:35], s51 offen offset:48
    s_mov_b64 exec, s[54:55]
    s_lshr_b32 s48, s18, 4
    v_lshlrev_b32 v9, 4, v1
    s_mov_b32 s36, s60
    s_mov_b32 s37, s61
    s_mov_b32 s38, 524288
    s_mov_b32 s39, 0x20000
    s_mov_b32 s44, s56
    s_mov_b32 s45, s57
    s_mov_b32 s46, 917504
    s_mov_b32 s47, 0x20000
    s_lshl_b32 s49, s48, 12
    buffer_load_dwordx4 v[128:131], v9, s[36:39], s49 offen offset:0
    buffer_load_dwordx4 v[132:135], v9, s[36:39], s49 offen offset:1024
    buffer_load_dwordx4 v[136:139], v9, s[36:39], s49 offen offset:2048
    buffer_load_dwordx4 v[140:143], v9, s[36:39], s49 offen offset:3072
    s_mul_i32 s49, s48, 7168
    buffer_load_dwordx4 v[144:147], v9, s[44:47], s49 offen offset:0
    buffer_load_dwordx4 v[148:151], v9, s[44:47], s49 offen offset:1024
    buffer_load_dwordx4 v[152:155], v9, s[44:47], s49 offen offset:2048
    buffer_load_dwordx4 v[156:159], v9, s[44:47], s49 offen offset:3072
    s_add_u32 s49, s49, 4096
    buffer_load_dwordx4 v[160:163], v9, s[44:47], s49 offen offset:0
    buffer_load_dwordx4 v[164:167], v9, s[44:47], s49 offen offset:1024
    buffer_load_dwordx4 v[168:171], v9, s[44:47], s49 offen offset:2048
    s_mov_b32 s80, s10
    s_mov_b32 s81, s11
    s_mov_b32 s82, 8388608
    s_mov_b32 s83, 0x20000
    s_lshr_b32 s43, s16, 1
    s_lshl_b32 s43, s43, 21
    s_lshl_b32 s44, s17, 16
    s_add_u32 s43, s43, s44
    s_lshl_b32 s44, s20, 13
    s_add_u32 s43, s43, s44
    buffer_load_dwordx4 v[64:67], v9, s[80:83], s43 offen offset:0
    buffer_load_dwordx4 v[68:71], v9, s[80:83], s43 offen offset:1024
    buffer_load_dwordx4 v[72:75], v9, s[80:83], s43 offen offset:2048
    buffer_load_dwordx4 v[76:79], v9, s[80:83], s43 offen offset:3072
    s_add_u32 s43, s43, 4096
    buffer_load_dwordx4 v[80:83], v9, s[80:83], s43 offen offset:0
    buffer_load_dwordx4 v[84:87], v9, s[80:83], s43 offen offset:1024
    buffer_load_dwordx4 v[88:91], v9, s[80:83], s43 offen offset:2048
    buffer_load_dwordx4 v[92:95], v9, s[80:83], s43 offen offset:3072
    s_waitcnt vmcnt(0)
K1_fin:
K1_fin2:
K1_end:
    s_endpgm
.globl gm_k2_kernel
.p2align 8
.type gm_k2_kernel,@function
gm_k2_kernel:
    s_cmp_ge_u32 s2, 512
    s_cbranch_scc1 K2_end
    s_load_dwordx2 s[4:5], s[0:1], 40
    s_load_dwordx2 s[6:7], s[0:1], 48
    s_load_dwordx2 s[10:11], s[0:1], 88
    s_load_dwordx2 s[56:57], s[0:1], 16
    s_load_dwordx2 s[58:59], s[0:1], 56
    s_load_dwordx2 s[60:61], s[0:1], 72
    v_lshrrev_b32 v2, 6, v0
    v_and_b32 v1, 63, v0
    v_readfirstlane_b32 s20, v2
    s_cmp_ge_u32 s2, 256
    s_cbranch_scc1 K2_attn
    s_setprio 1
    s_and_b32 s16, s2, 7
    s_lshr_b32 s17, s2, 3
    s_lshr_b32 s18, s16, 1
    s_lshl_b32 s18, s18, 3
    s_and_b32 s43, s17, 7
    s_add_u32 s18, s18, s43
    s_and_b32 s19, s16, 1
    s_lshl_b32 s19, s19, 2
    s_lshr_b32 s43, s17, 3
    s_add_u32 s19, s19, s43
    s_and_b32 s21, s16, 1
    s_lshl_b32 s21, s21, 4
    s_mul_i32 s22, s19, 7
    s_lshl_b32 s43, s20, 1
    s_add_u32 s22, s22, s43
    v_and_b32 v2, 15, v1
    v_lshrrev_b32 v3, 4, v1
    v_lshrrev_b32 v4, 3, v1
    v_and_b32 v5, 7, v1
    v_lshrrev_b32 v6, 1, v4
    v_xor_b32 v5, v5, v6
    s_lshl_b32 s43, s18, 6
    s_lshl_b32 s44, s20, 4
    s_add_u32 s43, s43, s44
    v_add_u32 v4, s43, v4
    v_lshlrev_b32 v4, 12, v4
    v_lshl_add_u32 v202, v5, 4, v4
    v_xor_b32 v5, 4, v5
    v_lshl_add_u32 v5, v5, 4, v4
    v_add_u32 v203, 31744, v5
    v_lshlrev_b32 v204, 4, v1
    s_lshl_b32 s47, s20, 11
    s_lshl_b32 s48, s22, 16
    s_add_u32 s48, s48, 10485760
    s_waitcnt lgkmcnt(0)
    s_mov_b32 s24, s4
    s_mov_b32 s25, s5
    s_mov_b32 s26, 8388608
    s_mov_b32 s27, 0x20000
    s_mov_b32 s32, s10
    s_mov_b32 s33, s11
    s_mov_b32 s34, 22020096
    s_mov_b32 s35, 0x20000
    s_mov_b32 s28, s6
    s_mov_b32 s29, s7
    s_mov_b32 s30, 4096
    s_mov_b32 s31, 0x20000
    s_cmp_eq_u32 s20, 3
    s_cbranch_scc1 K2_gw3
    s_mov_b32 s45, s21
    s_mov_b32 s46, s21
    s_lshl_b32 s43, s45, 7
    s_add_u32 s45, s45, 1
    s_and_b32 s45, s45, 31
    s_add_u32 m0, s47, 0
    s_nop 0
    buffer_load_dwordx4 v202, s[24:27], s43 offen offset:0  lds
    buffer_load_dwordx4 v203, s[24:27], s43 offen offset:1024  lds
    s_lshl_b32 s43, s45, 7
    s_add_u32 s45, s45, 1
    s_and_b32 s45, s45, 31
    s_add_u32 m0, s47, 8192
    s_nop 0
    buffer_load_dwordx4 v202, s[24:27], s43 offen offset:0  lds
    buffer_load_dwordx4 v203, s[24:27], s43 offen offset:1024  lds
    s_lshl_b32 s44, s46, 11
    s_add_u32 s44, s44, s48
    s_add_u32 s49, s44, 65536
    s_add_u32 s46, s46, 1
    s_and_b32 s46, s46, 31
    buffer_load_dwordx4 v[112:115], v204, s[32:35], s44 offen offset:0
    buffer_load_dwordx4 v[116:119], v204, s[32:35], s44 offen offset:1024
    buffer_load_dwordx4 v[120:123], v204, s[32:35], s49 offen offset:0
    buffer_load_dwordx4 v[124:127], v204, s[32:35], s49 offen offset:1024
    s_lshl_b32 s43, s45, 7
    s_add_u32 s45, s45, 1
    s_and_b32 s45, s45, 31
    s_add_u32 m0, s47, 16384
    s_nop 0
    buffer_load_dwordx4 v202, s[24:27], s43 offen offset:0  lds
    buffer_load_dwordx4 v203, s[24:27], s43 offen offset:1024  lds
    s_lshl_b32 s44, s46, 11
    s_add_u32 s44, s44, s48
    s_add_u32 s49, s44, 65536
    s_add_u32 s46, s46, 1
    s_and_b32 s46, s46, 31
    buffer_load_dwordx4 v[128:131], v204, s[32:35], s44 offen offset:0
    buffer_load_dwordx4 v[132:135], v204, s[32:35], s44 offen offset:1024
    buffer_load_dwordx4 v[136:139], v204, s[32:35], s49 offen offset:0
    buffer_load_dwordx4 v[140:143], v204, s[32:35], s49 offen offset:1024
    s_lshl_b32 s43, s45, 7
    s_add_u32 s45, s45, 1
    s_and_b32 s45, s45, 31
    s_add_u32 m0, s47, 24576
    s_nop 0
    buffer_load_dwordx4 v202, s[24:27], s43 offen offset:0  lds
    buffer_load_dwordx4 v203, s[24:27], s43 offen offset:1024  lds
    s_lshl_b32 s44, s46, 11
    s_add_u32 s44, s44, s48
    s_add_u32 s49, s44, 65536
    s_add_u32 s46, s46, 1
    s_and_b32 s46, s46, 31
    buffer_load_dwordx4 v[144:147], v204, s[32:35], s44 offen offset:0
    buffer_load_dwordx4 v[148:151], v204, s[32:35], s44 offen offset:1024
    buffer_load_dwordx4 v[152:155], v204, s[32:35], s49 offen offset:0
    buffer_load_dwordx4 v[156:159], v204, s[32:35], s49 offen offset:1024
    v_mov_b32 v16, 0
    v_mov_b32 v17, 0
    v_mov_b32 v18, 0
    v_mov_b32 v19, 0
    v_mov_b32 v20, 0
    v_mov_b32 v21, 0
    v_mov_b32 v22, 0
    v_mov_b32 v23, 0
    v_mov_b32 v24, 0
    v_mov_b32 v25, 0
    v_mov_b32 v26, 0
    v_mov_b32 v27, 0
    v_mov_b32 v28, 0
    v_mov_b32 v29, 0
    v_mov_b32 v30, 0
    v_mov_b32 v31, 0
    v_mov_b32 v32, 0
    v_mov_b32 v33, 0
    v_mov_b32 v34, 0
    v_mov_b32 v35, 0
    v_mov_b32 v36, 0
    v_mov_b32 v37, 0
    v_mov_b32 v38, 0
    v_mov_b32 v39, 0
    v_mov_b32 v40, 0
    v_mov_b32 v41, 0
    v_mov_b32 v42, 0
    v_mov_b32 v43, 0
    v_mov_b32 v44, 0
    v_mov_b32 v45, 0
    v_mov_b32 v46, 0
    v_mov_b32 v47, 0
    v_lshrrev_b32 v4, 1, v2
    v_xor_b32 v4, v4, v3
    v_lshlrev_b32 v5, 7, v2
    v_lshl_add_u32 v200, v4, 4, v5
    v_xor_b32 v201, 64, v200
    v_mov_b32 v206, 0xc0135761
    v_mov_b32 v207, 0xc0135761
    v_mov_b32 v208, 0xbdd2d3e8
    v_mov_b32 v209, 0xbdd2d3e8
    v_mov_b32 v210, 1.0
    v_mov_b32 v211, 1.0
    s_waitcnt vmcnt(18)
    s_barrier
    ds_read_b128 v[48:51], v200 offset:0
    ds_read_b128 v[52:55], v200 offset:2048
    ds_read_b128 v[56:59], v200 offset:4096
    ds_read_b128 v[60:63], v200 offset:6144
    ds_read_b128 v[64:67], v201 offset:0
    ds_read_b128 v[68:71], v201 offset:2048
    ds_read_b128 v[72:75], v201 offset:4096
    ds_read_b128 v[76:79], v201 offset:6144
    s_mov_b32 s40, 0
    s_lshl_b32 s43, s45, 7
    s_add_u32 s45, s45, 1
    s_and_b32 s45, s45, 31
    s_add_u32 m0, s47, 0
    s_lshl_b32 s44, s46, 11
    s_add_u32 s44, s44, s48
    s_add_u32 s49, s44, 65536
    s_add_u32 s46, s46, 1
    s_and_b32 s46, s46, 31
.p2align 6
K2_gloop_2:
    s_waitcnt vmcnt(12) lgkmcnt(0)
    s_barrier
    buffer_load_dwordx4 v202, s[24:27], s43 offen offset:0  lds
    v_mfma_f32_16x16x32_bf16 v[16:19], v[112:115], v[48:51], v[16:19]
    ds_read_b128 v[80:83], v200 offset:8192
    ds_read_b128 v[84:87], v200 offset:10240
    v_mfma_f32_16x16x32_bf16 v[20:23], v[112:115], v[52:55], v[20:23]
    ds_read_b128 v[88:91], v200 offset:12288
    v_mfma_f32_16x16x32_bf16 v[24:27], v[112:115], v[56:59], v[24:27]
    ds_read_b128 v[92:95], v200 offset:14336
    buffer_load_dwordx4 v203, s[24:27], s43 offen offset:1024  lds
    v_mfma_f32_16x16x32_bf16 v[28:31], v[112:115], v[60:63], v[28:31]
    ds_read_b128 v[96:99], v201 offset:8192
    v_mfma_f32_16x16x32_bf16 v[32:35], v[120:123], v[48:51], v[32:35]
    ds_read_b128 v[100:103], v201 offset:10240
    v_mfma_f32_16x16x32_bf16 v[36:39], v[120:123], v[52:55], v[36:39]
    ds_read_b128 v[104:107], v201 offset:12288
    buffer_load_dwordx4 v[160:163], v204, s[32:35], s44 offen offset:0
    v_mfma_f32_16x16x32_bf16 v[40:43], v[120:123], v[56:59], v[40:43]
    ds_read_b128 v[108:111], v201 offset:14336
    v_mfma_f32_16x16x32_bf16 v[44:47], v[120:123], v[60:63], v[44:47]
    s_lshl_b32 s53, s45, 7
    v_mfma_f32_16x16x32_bf16 v[16:19], v[116:119], v[64:67], v[16:19]
    s_add_u32 s45, s45, 1
    buffer_load_dwordx4 v[164:167], v204, s[32:35], s44 offen offset:1024
    v_mfma_f32_16x16x32_bf16 v[20:23], v[116:119], v[68:71], v[20:23]
    s_and_b32 s45, s45, 31
    v_mfma_f32_16x16x32_bf16 v[24:27], v[116:119], v[72:75], v[24:27]
    s_lshl_b32 s54, s46, 11
    v_mfma_f32_16x16x32_bf16 v[28:31], v[116:119], v[76:79], v[28:31]
    s_add_u32 s54, s54, s48
    buffer_load_dwordx4 v[168:171], v204, s[32:35], s49 offen offset:0
    v_mfma_f32_16x16x32_bf16 v[32:35], v[124:127], v[64:67], v[32:35]
    s_add_u32 s55, s54, 65536
    v_mfma_f32_16x16x32_bf16 v[36:39], v[124:127], v[68:71], v[36:39]
    s_add_u32 s46, s46, 1
    v_mfma_f32_16x16x32_bf16 v[40:43], v[124:127], v[72:75], v[40:43]
    s_and_b32 s46, s46, 31
    v_mfma_f32_16x16x32_bf16 v[44:47], v[124:127], v[76:79], v[44:47]
    s_add_u32 m0, s47, 8192
    buffer_load_dwordx4 v[172:175], v204, s[32:35], s49 offen offset:1024
    s_waitcnt vmcnt(12) lgkmcnt(0)
    s_barrier
    buffer_load_dwordx4 v202, s[24:27], s53 offen offset:0  lds
    v_mfma_f32_16x16x32_bf16 v[16:19], v[128:131], v[80:83], v[16:19]
    ds_read_b128 v[48:51], v200 offset:16384
    ds_read_b128 v[52:55], v200 offset:18432
    v_mfma_f32_16x16x32_bf16 v[20:23], v[128:131], v[84:87], v[20:23]
    ds_read_b128 v[56:59], v200 offset:20480
    v_mfma_f32_16x16x32_bf16 v[24:27], v[128:131], v[88:91], v[24:27]
    ds_read_b128 v[60:63], v200 offset:22528
    buffer_load_dwordx4 v203, s[24:27], s53 offen offset:1024  lds
    v_mfma_f32_16x16x32_bf16 v[28:31], v[128:131], v[92:95], v[28:31]
    ds_read_b128 v[64:67], v201 offset:16384
    v_mfma_f32_16x16x32_bf16 v[32:35], v[136:139], v[80:83], v[32:35]
    ds_read_b128 v[68:71], v201 offset:18432
    v_mfma_f32_16x16x32_bf16 v[36:39], v[136:139], v[84:87], v[36:39]
    ds_read_b128 v[72:75], v201 offset:20480
    buffer_load_dwordx4 v[112:115], v204, s[32:35], s54 offen offset:0
    v_mfma_f32_16x16x32_bf16 v[40:43], v[136:139], v[88:91], v[40:43]
    ds_read_b128 v[76:79], v201 offset:22528
    v_mfma_f32_16x16x32_bf16 v[44:47], v[136:139], v[92:95], v[44:47]
    s_lshl_b32 s43, s45, 7
    v_mfma_f32_16x16x32_bf16 v[16:19], v[132:135], v[96:99], v[16:19]
    s_add_u32 s45, s45, 1
    buffer_load_dwordx4 v[116:119], v204, s[32:35], s54 offen offset:1024
    v_mfma_f32_16x16x32_bf16 v[20:23], v[132:135], v[100:103], v[20:23]
    s_and_b32 s45, s45, 31
    v_mfma_f32_16x16x32_bf16 v[24:27], v[132:135], v[104:107], v[24:27]
    s_lshl_b32 s44, s46, 11
    v_mfma_f32_16x16x32_bf16 v[28:31], v[132:135], v[108:111], v[28:31]
    s_add_u32 s44, s44, s48
    buffer_load_dwordx4 v[120:123], v204, s[32:35], s55 offen offset:0
    v_mfma_f32_16x16x32_bf16 v[32:35], v[140:143], v[96:99], v[32:35]
    s_add_u32 s49, s44, 65536
    v_mfma_f32_16x16x32_bf16 v[36:39], v[140:143], v[100:103], v[36:39]
    s_add_u32 s46, s46, 1
    v_mfma_f32_16x16x32_bf16 v[40:43], v[140:143], v[104:107], v[40:43]
    s_and_b32 s46, s46, 31
    v_mfma_f32_16x16x32_bf16 v[44:47], v[140:143], v[108:111], v[44:47]
    s_add_u32 m0, s47, 16384
    buffer_load_dwordx4 v[124:127], v204, s[32:35], s55 offen offset:1024
    s_waitcnt vmcnt(12) lgkmcnt(0)
    s_barrier
    buffer_load_dwordx4 v202, s[24:27], s43 offen offset:0  lds
    v_mfma_f32_16x16x32_bf16 v[16:19], v[144:147], v[48:51], v[16:19]
    ds_read_b128 v[80:83], v200 offset:24576
    ds_read_b128 v[84:87], v200 offset:26624
    v_mfma_f32_16x16x32_bf16 v[20:23], v[144:147], v[52:55], v[20:23]
    ds_read_b128 v[88:91], v200 offset:28672
    v_mfma_f32_16x16x32_bf16 v[24:27], v[144:147], v[56:59], v[24:27]
    ds_read_b128 v[92:95], v200 offset:30720
    buffer_load_dwordx4 v203, s[24:27], s43 offen offset:1024  lds
    v_mfma_f32_16x16x32_bf16 v[28:31], v[144:147], v[60:63], v[28:31]
    ds_read_b128 v[96:99], v201 offset:24576
    v_mfma_f32_16x16x32_bf16 v[32:35], v[152:155], v[48:51], v[32:35]
    ds_read_b128 v[100:103], v201 offset:26624
    v_mfma_f32_16x16x32_bf16 v[36:39], v[152:155], v[52:55], v[36:39]
    ds_read_b128 v[104:107], v201 offset:28672
    buffer_load_dwordx4 v[128:131], v204, s[32:35], s44 offen offset:0
    v_mfma_f32_16x16x32_bf16 v[40:43], v[152:155], v[56:59], v[40:43]
    ds_read_b128 v[108:111], v201 offset:30720
    v_mfma_f32_16x16x32_bf16 v[44:47], v[152:155], v[60:63], v[44:47]
    s_lshl_b32 s53, s45, 7
    v_mfma_f32_16x16x32_bf16 v[16:19], v[148:151], v[64:67], v[16:19]
    s_add_u32 s45, s45, 1
    buffer_load_dwordx4 v[132:135], v204, s[32:35], s44 offen offset:1024
    v_mfma_f32_16x16x32_bf16 v[20:23], v[148:151], v[68:71], v[20:23]
    s_and_b32 s45, s45, 31
    v_mfma_f32_16x16x32_bf16 v[24:27], v[148:151], v[72:75], v[24:27]
    s_lshl_b32 s54, s46, 11
    v_mfma_f32_16x16x32_bf16 v[28:31], v[148:151], v[76:79], v[28:31]
    s_add_u32 s54, s54, s48
    buffer_load_dwordx4 v[136:139], v204, s[32:35], s49 offen offset:0
    v_mfma_f32_16x16x32_bf16 v[32:35], v[156:159], v[64:67], v[32:35]
    s_add_u32 s55, s54, 65536
    v_mfma_f32_16x16x32_bf16 v[36:39], v[156:159], v[68:71], v[36:39]
    s_add_u32 s46, s46, 1
    v_mfma_f32_16x16x32_bf16 v[40:43], v[156:159], v[72:75], v[40:43]
    s_and_b32 s46, s46, 31
    v_mfma_f32_16x16x32_bf16 v[44:47], v[156:159], v[76:79], v[44:47]
    s_add_u32 m0, s47, 24576
    buffer_load_dwordx4 v[140:143], v204, s[32:35], s49 offen offset:1024
    s_waitcnt vmcnt(12) lgkmcnt(0)
    s_barrier
    buffer_load_dwordx4 v202, s[24:27], s53 offen offset:0  lds
    v_mfma_f32_16x16x32_bf16 v[16:19], v[160:163], v[80:83], v[16:19]
    ds_read_b128 v[48:51], v200 offset:0
    ds_read_b128 v[52:55], v200 offset:2048
    v_mfma_f32_16x16x32_bf16 v[20:23], v[160:163], v[84:87], v[20:23]
    ds_read_b128 v[56:59], v200 offset:4096
    v_mfma_f32_16x16x32_bf16 v[24:27], v[160:163], v[88:91], v[24:27]
    ds_read_b128 v[60:63], v200 offset:6144
    buffer_load_dwordx4 v203, s[24:27], s53 offen offset:1024  lds
    v_mfma_f32_16x16x32_bf16 v[28:31], v[160:163], v[92:95], v[28:31]
    ds_read_b128 v[64:67], v201 offset:0
    v_mfma_f32_16x16x32_bf16 v[32:35], v[168:171], v[80:83], v[32:35]
    ds_read_b128 v[68:71], v201 offset:2048
    v_mfma_f32_16x16x32_bf16 v[36:39], v[168:171], v[84:87], v[36:39]
    ds_read_b128 v[72:75], v201 offset:4096
    ds_read_b128 v[76:79], v201 offset:6144
    buffer_load_dwordx4 v[144:147], v204, s[32:35], s54 offen offset:0
    v_mfma_f32_16x16x32_bf16 v[40:43], v[168:171], v[88:91], v[40:43]
    s_add_u32 s40, s40, 1
    v_mfma_f32_16x16x32_bf16 v[44:47], v[168:171], v[92:95], v[44:47]
    s_lshl_b32 s43, s45, 7
    v_mfma_f32_16x16x32_bf16 v[16:19], v[164:167], v[96:99], v[16:19]
    s_add_u32 s45, s45, 1
    buffer_load_dwordx4 v[148:151], v204, s[32:35], s54 offen offset:1024
    v_mfma_f32_16x16x32_bf16 v[20:23], v[164:167], v[100:103], v[20:23]
    s_and_b32 s45, s45, 31
    v_mfma_f32_16x16x32_bf16 v[24:27], v[164:167], v[104:107], v[24:27]
    s_lshl_b32 s44, s46, 11
    s_add_u32 s44, s44, s48
    v_mfma_f32_16x16x32_bf16 v[28:31], v[164:167], v[108:111], v[28:31]
    s_add_u32 s49, s44, 65536
    buffer_load_dwordx4 v[152:155], v204, s[32:35], s55 offen offset:0
    v_mfma_f32_16x16x32_bf16 v[32:35], v[172:175], v[96:99], v[32:35]
    s_add_u32 s46, s46, 1
    v_mfma_f32_16x16x32_bf16 v[36:39], v[172:175], v[100:103], v[36:39]
    s_and_b32 s46, s46, 31
    v_mfma_f32_16x16x32_bf16 v[40:43], v[172:175], v[104:107], v[40:43]
    s_add_u32 m0, s47, 0
    v_mfma_f32_16x16x32_bf16 v[44:47], v[172:175], v[108:111], v[44:47]
    s_cmp_lt_u32 s40, 6
    buffer_load_dwordx4 v[156:159], v204, s[32:35], s55 offen offset:1024
    s_cbranch_scc1 K2_gloop_2
K2_gtail_2:
    s_waitcnt vmcnt(12) lgkmcnt(0)
    s_barrier
    buffer_load_dwordx4 v202, s[24:27], s43 offen offset:0  lds
    v_mfma_f32_16x16x32_bf16 v[16:19], v[112:115], v[48:51], v[16:19]
    ds_read_b128 v[80:83], v200 offset:8192
    ds_read_b128 v[84:87], v200 offset:10240
    v_mfma_f32_16x16x32_bf16 v[20:23], v[112:115], v[52:55], v[20:23]
    ds_read_b128 v[88:91], v200 offset:12288
    v_mfma_f32_16x16x32_bf16 v[24:27], v[112:115], v[56:59], v[24:27]
    ds_read_b128 v[92:95], v200 offset:14336
    buffer_load_dwordx4 v203, s[24:27], s43 offen offset:1024  lds
    v_mfma_f32_16x16x32_bf16 v[28:31], v[112:115], v[60:63], v[28:31]
    ds_read_b128 v[96:99], v201 offset:8192
    v_mfma_f32_16x16x32_bf16 v[32:35], v[120:123], v[48:51], v[32:35]
    ds_read_b128 v[100:103], v201 offset:10240
    v_mfma_f32_16x16x32_bf16 v[36:39], v[120:123], v[52:55], v[36:39]
    ds_read_b128 v[104:107], v201 offset:12288
    buffer_load_dwordx4 v[160:163], v204, s[32:35], s44 offen offset:0
    v_mfma_f32_16x16x32_bf16 v[40:43], v[120:123], v[56:59], v[40:43]
    ds_read_b128 v[108:111], v201 offset:14336
    v_mfma_f32_16x16x32_bf16 v[44:47], v[120:123], v[60:63], v[44:47]
    s_lshl_b32 s53, s45, 7
    v_mfma_f32_16x16x32_bf16 v[16:19], v[116:119], v[64:67], v[16:19]
    s_add_u32 s45, s45, 1
    buffer_load_dwordx4 v[164:167], v204, s[32:35], s44 offen offset:1024
    v_mfma_f32_16x16x32_bf16 v[20:23], v[116:119], v[68:71], v[20:23]
    s_and_b32 s45, s45, 31
    v_mfma_f32_16x16x32_bf16 v[24:27], v[116:119], v[72:75], v[24:27]
    s_lshl_b32 s54, s46, 11
    v_mfma_f32_16x16x32_bf16 v[28:31], v[116:119], v[76:79], v[28:31]
    s_add_u32 s54, s54, s48
    buffer_load_dwordx4 v[168:171], v204, s[32:35], s49 offen offset:0
    v_mfma_f32_16x16x32_bf16 v[32:35], v[124:127], v[64:67], v[32:35]
    s_add_u32 s55, s54, 65536
    v_mfma_f32_16x16x32_bf16 v[36:39], v[124:127], v[68:71], v[36:39]
    s_add_u32 s46, s46, 1
    v_mfma_f32_16x16x32_bf16 v[40:43], v[124:127], v[72:75], v[40:43]
    s_and_b32 s46, s46, 31
    v_mfma_f32_16x16x32_bf16 v[44:47], v[124:127], v[76:79], v[44:47]
    s_add_u32 m0, s47, 8192
    buffer_load_dwordx4 v[172:175], v204, s[32:35], s49 offen offset:1024
    s_waitcnt vmcnt(12) lgkmcnt(0)
    s_barrier
    buffer_load_dwordx4 v202, s[24:27], s53 offen offset:0  lds
    v_mfma_f32_16x16x32_bf16 v[16:19], v[128:131], v[80:83], v[16:19]
    ds_read_b128 v[48:51], v200 offset:16384
    ds_read_b128 v[52:55], v200 offset:18432
    v_mfma_f32_16x16x32_bf16 v[20:23], v[128:131], v[84:87], v[20:23]
    ds_read_b128 v[56:59], v200 offset:20480
    v_mfma_f32_16x16x32_bf16 v[24:27], v[128:131], v[88:91], v[24:27]
    ds_read_b128 v[60:63], v200 offset:22528
    buffer_load_dwordx4 v203, s[24:27], s53 offen offset:1024  lds
    v_mfma_f32_16x16x32_bf16 v[28:31], v[128:131], v[92:95], v[28:31]
    ds_read_b128 v[64:67], v201 offset:16384
    v_mfma_f32_16x16x32_bf16 v[32:35], v[136:139], v[80:83], v[32:35]
    ds_read_b128 v[68:71], v201 offset:18432
    v_mfma_f32_16x16x32_bf16 v[36:39], v[136:139], v[84:87], v[36:39]
    ds_read_b128 v[72:75], v201 offset:20480
    buffer_load_dwordx4 v[112:115], v204, s[32:35], s54 offen offset:0
    v_mfma_f32_16x16x32_bf16 v[40:43], v[136:139], v[88:91], v[40:43]
    ds_read_b128 v[76:79], v201 offset:22528
    v_mfma_f32_16x16x32_bf16 v[44:47], v[136:139], v[92:95], v[44:47]
    s_lshl_b32 s43, s45, 7
    v_mfma_f32_16x16x32_bf16 v[16:19], v[132:135], v[96:99], v[16:19]
    s_add_u32 s45, s45, 1
    buffer_load_dwordx4 v[116:119], v204, s[32:35], s54 offen offset:1024
    v_mfma_f32_16x16x32_bf16 v[20:23], v[132:135], v[100:103], v[20:23]
    s_and_b32 s45, s45, 31
    v_mfma_f32_16x16x32_bf16 v[24:27], v[132:135], v[104:107], v[24:27]
    s_lshl_b32 s44, s46, 11
    v_mfma_f32_16x16x32_bf16 v[28:31], v[132:135], v[108:111], v[28:31]
    s_add_u32 s44, s44, s48
    buffer_load_dwordx4 v[120:123], v204, s[32:35], s55 offen offset:0
    v_mfma_f32_16x16x32_bf16 v[32:35], v[140:143], v[96:99], v[32:35]
    s_add_u32 s49, s44, 65536
    v_mfma_f32_16x16x32_bf16 v[36:39], v[140:143], v[100:103], v[36:39]
    s_add_u32 s46, s46, 1
    v_mfma_f32_16x16x32_bf16 v[40:43], v[140:143], v[104:107], v[40:43]
    s_and_b32 s46, s46, 31
    v_mfma_f32_16x16x32_bf16 v[44:47], v[140:143], v[108:111], v[44:47]
    s_add_u32 m0, s47, 16384
    buffer_load_dwordx4 v[124:127], v204, s[32:35], s55 offen offset:1024
    s_waitcnt vmcnt(12) lgkmcnt(0)
    s_barrier
    buffer_load_dwordx4 v202, s[24:27], s43 offen offset:0  lds
    v_mfma_f32_16x16x32_bf16 v[16:19], v[144:147], v[48:51], v[16:19]
    ds_read_b128 v[80:83], v200 offset:24576
    ds_read_b128 v[84:87], v200 offset:26624
    v_mfma_f32_16x16x32_bf16 v[20:23], v[144:147], v[52:55], v[20:23]
    ds_read_b128 v[88:91], v200 offset:28672
    v_mfma_f32_16x16x32_bf16 v[24:27], v[144:147], v[56:59], v[24:27]
    ds_read_b128 v[92:95], v200 offset:30720
    buffer_load_dwordx4 v203, s[24:27], s43 offen offset:1024  lds
    v_mfma_f32_16x16x32_bf16 v[28:31], v[144:147], v[60:63], v[28:31]
    ds_read_b128 v[96:99], v201 offset:24576
    v_mfma_f32_16x16x32_bf16 v[32:35], v[152:155], v[48:51], v[32:35]
    ds_read_b128 v[100:103], v201 offset:26624
    v_mfma_f32_16x16x32_bf16 v[36:39], v[152:155], v[52:55], v[36:39]
    ds_read_b128 v[104:107], v201 offset:28672
    buffer_load_dwordx4 v[128:131], v204, s[32:35], s44 offen offset:0
    v_mfma_f32_16x16x32_bf16 v[40:43], v[152:155], v[56:59], v[40:43]
    ds_read_b128 v[108:111], v201 offset:30720
    v_mfma_f32_16x16x32_bf16 v[44:47], v[152:155], v[60:63], v[44:47]
    s_lshl_b32 s53, s45, 7
    v_mfma_f32_16x16x32_bf16 v[16:19], v[148:151], v[64:67], v[16:19]
    s_add_u32 s45, s45, 1
    buffer_load_dwordx4 v[132:135], v204, s[32:35], s44 offen offset:1024
    v_mfma_f32_16x16x32_bf16 v[20:23], v[148:151], v[68:71], v[20:23]
    s_and_b32 s45, s45, 31
    v_mfma_f32_16x16x32_bf16 v[24:27], v[148:151], v[72:75], v[24:27]
    s_lshl_b32 s54, s46, 11
    v_mfma_f32_16x16x32_bf16 v[28:31], v[148:151], v[76:79], v[28:31]
    s_add_u32 s54, s54, s48
    buffer_load_dwordx4 v[136:139], v204, s[32:35], s49 offen offset:0
    v_mfma_f32_16x16x32_bf16 v[32:35], v[156:159], v[64:67], v[32:35]
    s_add_u32 s55, s54, 65536
    v_mfma_f32_16x16x32_bf16 v[36:39], v[156:159], v[68:71], v[36:39]
    s_add_u32 s46, s46, 1
    v_mfma_f32_16x16x32_bf16 v[40:43], v[156:159], v[72:75], v[40:43]
    s_and_b32 s46, s46, 31
    v_mfma_f32_16x16x32_bf16 v[44:47], v[156:159], v[76:79], v[44:47]
    s_add_u32 m0, s47, 24576
    buffer_load_dwordx4 v[140:143], v204, s[32:35], s49 offen offset:1024
    s_waitcnt vmcnt(12) lgkmcnt(0)
    s_barrier
    buffer_load_dwordx4 v202, s[24:27], s53 offen offset:0  lds
    v_mfma_f32_16x16x32_bf16 v[16:19], v[160:163], v[80:83], v[16:19]
    ds_read_b128 v[48:51], v200 offset:0
    v_mfma_f32_16x16x32_bf16 v[20:23], v[160:163], v[84:87], v[20:23]
    ds_read_b128 v[52:55], v200 offset:2048
    v_mfma_f32_16x16x32_bf16 v[24:27], v[160:163], v[88:91], v[24:27]
    ds_read_b128 v[56:59], v200 offset:4096
    buffer_load_dwordx4 v203, s[24:27], s53 offen offset:1024  lds
    v_mfma_f32_16x16x32_bf16 v[28:31], v[160:163], v[92:95], v[28:31]
    ds_read_b128 v[60:63], v200 offset:6144
    v_mfma_f32_16x16x32_bf16 v[32:35], v[168:171], v[80:83], v[32:35]
    ds_read_b128 v[64:67], v201 offset:0
    v_mfma_f32_16x16x32_bf16 v[36:39], v[168:171], v[84:87], v[36:39]
    buffer_load_dwordx4 v[144:147], v204, s[32:35], s54 offen offset:0
    v_mfma_f32_16x16x32_bf16 v[40:43], v[168:171], v[88:91], v[40:43]
    ds_read_b128 v[68:71], v201 offset:2048
    v_mfma_f32_16x16x32_bf16 v[44:47], v[168:171], v[92:95], v[44:47]
    ds_read_b128 v[72:75], v201 offset:4096
    v_mfma_f32_16x16x32_bf16 v[16:19], v[164:167], v[96:99], v[16:19]
    ds_read_b128 v[76:79], v201 offset:6144
    buffer_load_dwordx4 v[148:151], v204, s[32:35], s54 offen offset:1024
    v_mfma_f32_16x16x32_bf16 v[20:23], v[164:167], v[100:103], v[20:23]
    s_lshl_b32 s44, s46, 11
    v_mfma_f32_16x16x32_bf16 v[24:27], v[164:167], v[104:107], v[24:27]
    v_mfma_f32_16x16x32_bf16 v[28:31], v[164:167], v[108:111], v[28:31]
    s_add_u32 s44, s44, s48
    buffer_load_dwordx4 v[152:155], v204, s[32:35], s55 offen offset:0
    v_mfma_f32_16x16x32_bf16 v[32:35], v[172:175], v[96:99], v[32:35]
    s_add_u32 s49, s44, 65536
    v_mfma_f32_16x16x32_bf16 v[36:39], v[172:175], v[100:103], v[36:39]
    s_add_u32 s46, s46, 1
    v_mfma_f32_16x16x32_bf16 v[40:43], v[172:175], v[104:107], v[40:43]
    s_and_b32 s46, s46, 31
    v_mfma_f32_16x16x32_bf16 v[44:47], v[172:175], v[108:111], v[44:47]
    buffer_load_dwordx4 v[156:159], v204, s[32:35], s55 offen offset:1024
    s_waitcnt vmcnt(12) lgkmcnt(0)
    s_barrier
    buffer_load_dwordx4 v[160:163], v204, s[32:35], s44 offen offset:0
    v_mfma_f32_16x16x32_bf16 v[16:19], v[112:115], v[48:51], v[16:19]
    ds_read_b128 v[80:83], v200 offset:8192
    v_mfma_f32_16x16x32_bf16 v[20:23], v[112:115], v[52:55], v[20:23]
    v_mfma_f32_16x16x32_bf16 v[24:27], v[112:115], v[56:59], v[24:27]
    ds_read_b128 v[84:87], v200 offset:10240
    v_mfma_f32_16x16x32_bf16 v[28:31], v[112:115], v[60:63], v[28:31]
    v_mfma_f32_16x16x32_bf16 v[32:35], v[120:123], v[48:51], v[32:35]
    ds_read_b128 v[88:91], v200 offset:12288
    buffer_load_dwordx4 v[164:167], v204, s[32:35], s44 offen offset:1024
    v_mfma_f32_16x16x32_bf16 v[36:39], v[120:123], v[52:55], v[36:39]
    v_mfma_f32_16x16x32_bf16 v[40:43], v[120:123], v[56:59], v[40:43]
    ds_read_b128 v[92:95], v200 offset:14336
    v_mfma_f32_16x16x32_bf16 v[44:47], v[120:123], v[60:63], v[44:47]
    v_mfma_f32_16x16x32_bf16 v[16:19], v[116:119], v[64:67], v[16:19]
    ds_read_b128 v[96:99], v201 offset:8192
    v_mfma_f32_16x16x32_bf16 v[20:23], v[116:119], v[68:71], v[20:23]
    buffer_load_dwordx4 v[168:171], v204, s[32:35], s49 offen offset:0
    v_mfma_f32_16x16x32_bf16 v[24:27], v[116:119], v[72:75], v[24:27]
    ds_read_b128 v[100:103], v201 offset:10240
    v_mfma_f32_16x16x32_bf16 v[28:31], v[116:119], v[76:79], v[28:31]
    v_mfma_f32_16x16x32_bf16 v[32:35], v[124:127], v[64:67], v[32:35]
    ds_read_b128 v[104:107], v201 offset:12288
    v_mfma_f32_16x16x32_bf16 v[36:39], v[124:127], v[68:71], v[36:39]
    v_mfma_f32_16x16x32_bf16 v[40:43], v[124:127], v[72:75], v[40:43]
    ds_read_b128 v[108:111], v201 offset:14336
    v_mfma_f32_16x16x32_bf16 v[44:47], v[124:127], v[76:79], v[44:47]
    buffer_load_dwordx4 v[172:175], v204, s[32:35], s49 offen offset:1024
    v_lshlrev_b32 v4, 4, v1
    s_lshl_b32 s43, s18, 1
    s_mul_i32 s43, s43, 56
    s_add_u32 s43, s43, s22
    s_lshl_b32 s43, s43, 10
    s_add_u32 s43, s43, 6291456
    buffer_load_dwordx4 v[176:179], v4, s[32:35], s43 offen offset:0
    buffer_load_dwordx4 v[184:187], v4, s[32:35], s43 offen offset:1024
    s_add_u32 s43, s43, 57344
    buffer_load_dwordx4 v[180:183], v4, s[32:35], s43 offen offset:0
    buffer_load_dwordx4 v[188:191], v4, s[32:35], s43 offen offset:1024
    s_lshl_b32 s43, s18, 6
    v_add_u32 v5, s43, v2
    v_lshlrev_b32 v6, 1, v5
    v_lshlrev_b32 v7, 2, v5
    s_mov_b32 s44, 21495808
    buffer_load_ushort v192, v6, s[28:31], 0 offen offset:0
    buffer_load_dword v196, v7, s[32:35], s44 offen offset:0
    buffer_load_ushort v193, v6, s[28:31], 0 offen offset:32
    buffer_load_dword v197, v7, s[32:35], s44 offen offset:64
    buffer_load_ushort v194, v6, s[28:31], 0 offen offset:64
    buffer_load_dword v198, v7, s[32:35], s44 offen offset:128
    buffer_load_ushort v195, v6, s[28:31], 0 offen offset:96
    buffer_load_dword v199, v7, s[32:35], s44 offen offset:192
    s_waitcnt vmcnt(22) lgkmcnt(0)
    s_barrier
    v_mfma_f32_16x16x32_bf16 v[16:19], v[128:131], v[80:83], v[16:19]
    ds_read_b128 v[48:51], v200 offset:16384
    v_mfma_f32_16x16x32_bf16 v[20:23], v[128:131], v[84:87], v[20:23]
    v_mfma_f32_16x16x32_bf16 v[24:27], v[128:131], v[88:91], v[24:27]
    ds_read_b128 v[52:55], v200 offset:18432
    v_mfma_f32_16x16x32_bf16 v[28:31], v[128:131], v[92:95], v[28:31]
    v_mfma_f32_16x16x32_bf16 v[32:35], v[136:139], v[80:83], v[32:35]
    ds_read_b128 v[56:59], v200 offset:20480
    v_mfma_f32_16x16x32_bf16 v[36:39], v[136:139], v[84:87], v[36:39]
    v_mfma_f32_16x16x32_bf16 v[40:43], v[136:139], v[88:91], v[40:43]
    ds_read_b128 v[60:63], v200 offset:22528
    v_mfma_f32_16x16x32_bf16 v[44:47], v[136:139], v[92:95], v[44:47]
    v_mfma_f32_16x16x32_bf16 v[16:19], v[132:135], v[96:99], v[16:19]
    ds_read_b128 v[64:67], v201 offset:16384
    v_mfma_f32_16x16x32_bf16 v[20:23], v[132:135], v[100:103], v[20:23]
    v_mfma_f32_16x16x32_bf16 v[24:27], v[132:135], v[104:107], v[24:27]
    ds_read_b128 v[68:71], v201 offset:18432
    v_mfma_f32_16x16x32_bf16 v[28:31], v[132:135], v[108:111], v[28:31]
    v_mfma_f32_16x16x32_bf16 v[32:35], v[140:143], v[96:99], v[32:35]
    ds_read_b128 v[72:75], v201 offset:20480
    v_mfma_f32_16x16x32_bf16 v[36:39], v[140:143], v[100:103], v[36:39]
    v_mfma_f32_16x16x32_bf16 v[40:43], v[140:143], v[104:107], v[40:43]
    ds_read_b128 v[76:79], v201 offset:22528
    v_mfma_f32_16x16x32_bf16 v[44:47], v[140:143], v[108:111], v[44:47]
    s_waitcnt vmcnt(16) lgkmcnt(0)
    s_barrier
    v_mfma_f32_16x16x32_bf16 v[16:19], v[144:147], v[48:51], v[16:19]
    ds_read_b128 v[80:83], v200 offset:24576
    v_mfma_f32_16x16x32_bf16 v[20:23], v[144:147], v[52:55], v[20:23]
    v_mfma_f32_16x16x32_bf16 v[24:27], v[144:147], v[56:59], v[24:27]
    ds_read_b128 v[84:87], v200 offset:26624
    v_mfma_f32_16x16x32_bf16 v[28:31], v[144:147], v[60:63], v[28:31]
    v_mfma_f32_16x16x32_bf16 v[32:35], v[152:155], v[48:51], v[32:35]
    ds_read_b128 v[88:91], v200 offset:28672
    v_mfma_f32_16x16x32_bf16 v[36:39], v[152:155], v[52:55], v[36:39]
    v_mfma_f32_16x16x32_bf16 v[40:43], v[152:155], v[56:59], v[40:43]
    ds_read_b128 v[92:95], v200 offset:30720
    v_mfma_f32_16x16x32_bf16 v[44:47], v[152:155], v[60:63], v[44:47]
    v_mfma_f32_16x16x32_bf16 v[16:19], v[148:151], v[64:67], v[16:19]
    ds_read_b128 v[96:99], v201 offset:24576
    v_mfma_f32_16x16x32_bf16 v[20:23], v[148:151], v[68:71], v[20:23]
    v_mfma_f32_16x16x32_bf16 v[24:27], v[148:151], v[72:75], v[24:27]
    ds_read_b128 v[100:103], v201 offset:26624
    v_mfma_f32_16x16x32_bf16 v[28:31], v[148:151], v[76:79], v[28:31]
    v_mfma_f32_16x16x32_bf16 v[32:35], v[156:159], v[64:67], v[32:35]
    ds_read_b128 v[104:107], v201 offset:28672
    v_mfma_f32_16x16x32_bf16 v[36:39], v[156:159], v[68:71], v[36:39]
    v_mfma_f32_16x16x32_bf16 v[40:43], v[156:159], v[72:75], v[40:43]
    ds_read_b128 v[108:111], v201 offset:30720
    v_mfma_f32_16x16x32_bf16 v[44:47], v[156:159], v[76:79], v[44:47]
    s_waitcnt vmcnt(12) lgkmcnt(0)
    s_barrier
    v_mfma_f32_16x16x32_bf16 v[16:19], v[160:163], v[80:83], v[16:19]
    v_mfma_f32_16x16x32_bf16 v[20:23], v[160:163], v[84:87], v[20:23]
    v_mfma_f32_16x16x32_bf16 v[24:27], v[160:163], v[88:91], v[24:27]
    v_mfma_f32_16x16x32_bf16 v[28:31], v[160:163], v[92:95], v[28:31]
    v_mfma_f32_16x16x32_bf16 v[32:35], v[168:171], v[80:83], v[32:35]
    v_mfma_f32_16x16x32_bf16 v[36:39], v[168:171], v[84:87], v[36:39]
    v_mfma_f32_16x16x32_bf16 v[40:43], v[168:171], v[88:91], v[40:43]
    v_mfma_f32_16x16x32_bf16 v[44:47], v[168:171], v[92:95], v[44:47]
    v_mfma_f32_16x16x32_bf16 v[16:19], v[164:167], v[96:99], v[16:19]
    v_mfma_f32_16x16x32_bf16 v[20:23], v[164:167], v[100:103], v[20:23]
    v_mfma_f32_16x16x32_bf16 v[24:27], v[164:167], v[104:107], v[24:27]
    v_mfma_f32_16x16x32_bf16 v[28:31], v[164:167], v[108:111], v[28:31]
    v_mfma_f32_16x16x32_bf16 v[32:35], v[172:175], v[96:99], v[32:35]
    v_mfma_f32_16x16x32_bf16 v[36:39], v[172:175], v[100:103], v[36:39]
    v_mfma_f32_16x16x32_bf16 v[40:43], v[172:175], v[104:107], v[40:43]
    v_mfma_f32_16x16x32_bf16 v[44:47], v[172:175], v[108:111], v[44:47]
    s_waitcnt vmcnt(0)
    v_lshlrev_b32 v4, 4, v2
    v_lshrrev_b32 v5, 1, v3
    v_lshl_add_u32 v4, v5, 8, v4
    v_and_b32 v5, 1, v3
    v_lshl_add_u32 v4, v5, 3, v4
    v_sub_f32 v196, 1.0, v196
    v_lshlrev_b32 v192, 16, v192
    v_sub_f32 v197, 1.0, v197
    v_lshlrev_b32 v193, 16, v193
    v_sub_f32 v198, 1.0, v198
    v_lshlrev_b32 v194, 16, v194
    v_sub_f32 v199, 1.0, v199
    v_lshlrev_b32 v195, 16, v195
    s_add_u32 s43, s22, 0
    s_and_b32 s44, s43, 1
    s_lshl_b32 s44, s44, 9
    s_lshr_b32 s43, s43, 1
    s_add_u32 s43, s43, 16
    s_mul_i32 s45, s18, 176
    s_add_u32 s43, s43, s45
    s_lshl_b32 s43, s43, 10
    s_add_u32 s43, s43, s44
    s_add_u32 s43, s43, 14680064
    v_lshlrev_b32 v48, 16, v176
    v_and_b32 v49, 0xffff0000, v176
    v_lshlrev_b32 v50, 16, v177
    v_and_b32 v51, 0xffff0000, v177
    v_lshlrev_b32 v52, 16, v178
    v_and_b32 v53, 0xffff0000, v178
    v_lshlrev_b32 v54, 16, v179
    v_and_b32 v55, 0xffff0000, v179
    v_pk_mul_f32 v[112:113], v[48:49], v[48:49]
    v_pk_mul_f32 v[114:115], v[50:51], v[50:51]
    v_pk_mul_f32 v[116:117], v[52:53], v[52:53]
    v_pk_mul_f32 v[118:119], v[54:55], v[54:55]
    v_pk_fma_f32 v[112:113], v[112:113], v[208:209], v[206:207]
    v_pk_fma_f32 v[114:115], v[114:115], v[208:209], v[206:207]
    v_pk_fma_f32 v[116:117], v[116:117], v[208:209], v[206:207]
    v_pk_fma_f32 v[118:119], v[118:119], v[208:209], v[206:207]
    v_pk_mul_f32 v[112:113], v[112:113], v[48:49]
    v_pk_mul_f32 v[114:115], v[114:115], v[50:51]
    v_pk_mul_f32 v[116:117], v[116:117], v[52:53]
    v_pk_mul_f32 v[118:119], v[118:119], v[54:55]
    v_exp_f32 v112, v112
    v_exp_f32 v113, v113
    v_exp_f32 v114, v114
    v_exp_f32 v115, v115
    v_exp_f32 v116, v116
    v_exp_f32 v117, v117
    v_exp_f32 v118, v118
    v_exp_f32 v119, v119
    v_pk_add_f32 v[112:113], v[112:113], v[210:211]
    v_pk_add_f32 v[114:115], v[114:115], v[210:211]
    v_pk_add_f32 v[116:117], v[116:117], v[210:211]
    v_pk_add_f32 v[118:119], v[118:119], v[210:211]
    v_rcp_f32 v112, v112
    v_rcp_f32 v113, v113
    v_rcp_f32 v114, v114
    v_rcp_f32 v115, v115
    v_rcp_f32 v116, v116
    v_rcp_f32 v117, v117
    v_rcp_f32 v118, v118
    v_rcp_f32 v119, v119
    v_pk_mul_f32 v[48:49], v[48:49], v[112:113]
    v_pk_mul_f32 v[50:51], v[50:51], v[114:115]
    v_pk_mul_f32 v[52:53], v[52:53], v[116:117]
    v_pk_mul_f32 v[54:55], v[54:55], v[118:119]
    v_pk_add_f32 v[16:17], v[16:17], v[192:193] op_sel:[0,0] op_sel_hi:[1,0]
    v_pk_mul_f32 v[48:49], v[48:49], v[196:197] op_sel:[0,0] op_sel_hi:[1,0]
    v_pk_add_f32 v[18:19], v[18:19], v[192:193] op_sel:[0,0] op_sel_hi:[1,0]
    v_pk_mul_f32 v[50:51], v[50:51], v[196:197] op_sel:[0,0] op_sel_hi:[1,0]
    v_pk_mul_f32 v[16:17], v[16:17], v[48:49]
    v_pk_mul_f32 v[18:19], v[18:19], v[50:51]
    v_cvt_pk_bf16_f32 v16, v16, v17
    v_cvt_pk_bf16_f32 v17, v18, v19
    buffer_store_dwordx2 v[16:17], v4, s[32:35], s43 offen sc1
    s_add_u32 s43, s43, 45056
    v_pk_add_f32 v[20:21], v[20:21], v[192:193] op_sel:[0,1] op_sel_hi:[1,1]
    v_pk_mul_f32 v[52:53], v[52:53], v[196:197] op_sel:[0,1] op_sel_hi:[1,1]
    v_pk_add_f32 v[22:23], v[22:23], v[192:193] op_sel:[0,1] op_sel_hi:[1,1]
    v_pk_mul_f32 v[54:55], v[54:55], v[196:197] op_sel:[0,1] op_sel_hi:[1,1]
    v_pk_mul_f32 v[20:21], v[20:21], v[52:53]
    v_pk_mul_f32 v[22:23], v[22:23], v[54:55]
    v_cvt_pk_bf16_f32 v20, v20, v21
    v_cvt_pk_bf16_f32 v21, v22, v23
    buffer_store_dwordx2 v[20:21], v4, s[32:35], s43 offen sc1
    s_add_u32 s43, s43, 45056
    v_lshlrev_b32 v56, 16, v180
    v_and_b32 v57, 0xffff0000, v180
    v_lshlrev_b32 v58, 16, v181
    v_and_b32 v59, 0xffff0000, v181
    v_lshlrev_b32 v60, 16, v182
    v_and_b32 v61, 0xffff0000, v182
    v_lshlrev_b32 v62, 16, v183
    v_and_b32 v63, 0xffff0000, v183
    v_pk_mul_f32 v[112:113], v[56:57], v[56:57]
    v_pk_mul_f32 v[114:115], v[58:59], v[58:59]
    v_pk_mul_f32 v[116:117], v[60:61], v[60:61]
    v_pk_mul_f32 v[118:119], v[62:63], v[62:63]
    v_pk_fma_f32 v[112:113], v[112:113], v[208:209], v[206:207]
    v_pk_fma_f32 v[114:115], v[114:115], v[208:209], v[206:207]
    v_pk_fma_f32 v[116:117], v[116:117], v[208:209], v[206:207]
    v_pk_fma_f32 v[118:119], v[118:119], v[208:209], v[206:207]
    v_pk_mul_f32 v[112:113], v[112:113], v[56:57]
    v_pk_mul_f32 v[114:115], v[114:115], v[58:59]
    v_pk_mul_f32 v[116:117], v[116:117], v[60:61]
    v_pk_mul_f32 v[118:119], v[118:119], v[62:63]
    v_exp_f32 v112, v112
    v_exp_f32 v113, v113
    v_exp_f32 v114, v114
    v_exp_f32 v115, v115
    v_exp_f32 v116, v116
    v_exp_f32 v117, v117
    v_exp_f32 v118, v118
    v_exp_f32 v119, v119
    v_pk_add_f32 v[112:113], v[112:113], v[210:211]
    v_pk_add_f32 v[114:115], v[114:115], v[210:211]
    v_pk_add_f32 v[116:117], v[116:117], v[210:211]
    v_pk_add_f32 v[118:119], v[118:119], v[210:211]
    v_rcp_f32 v112, v112
    v_rcp_f32 v113, v113
    v_rcp_f32 v114, v114
    v_rcp_f32 v115, v115
    v_rcp_f32 v116, v116
    v_rcp_f32 v117, v117
    v_rcp_f32 v118, v118
    v_rcp_f32 v119, v119
    v_pk_mul_f32 v[56:57], v[56:57], v[112:113]
    v_pk_mul_f32 v[58:59], v[58:59], v[114:115]
    v_pk_mul_f32 v[60:61], v[60:61], v[116:117]
    v_pk_mul_f32 v[62:63], v[62:63], v[118:119]
    v_pk_add_f32 v[24:25], v[24:25], v[194:195] op_sel:[0,0] op_sel_hi:[1,0]
    v_pk_mul_f32 v[56:57], v[56:57], v[198:199] op_sel:[0,0] op_sel_hi:[1,0]
    v_pk_add_f32 v[26:27], v[26:27], v[194:195] op_sel:[0,0] op_sel_hi:[1,0]
    v_pk_mul_f32 v[58:59], v[58:59], v[198:199] op_sel:[0,0] op_sel_hi:[1,0]
    v_pk_mul_f32 v[24:25], v[24:25], v[56:57]
    v_pk_mul_f32 v[26:27], v[26:27], v[58:59]
    v_cvt_pk_bf16_f32 v24, v24, v25
    v_cvt_pk_bf16_f32 v25, v26, v27
    buffer_store_dwordx2 v[24:25], v4, s[32:35], s43 offen sc1
    s_add_u32 s43, s43, 45056
    v_pk_add_f32 v[28:29], v[28:29], v[194:195] op_sel:[0,1] op_sel_hi:[1,1]
    v_pk_mul_f32 v[60:61], v[60:61], v[198:199] op_sel:[0,1] op_sel_hi:[1,1]
    v_pk_add_f32 v[30:31], v[30:31], v[194:195] op_sel:[0,1] op_sel_hi:[1,1]
    v_pk_mul_f32 v[62:63], v[62:63], v[198:199] op_sel:[0,1] op_sel_hi:[1,1]
    v_pk_mul_f32 v[28:29], v[28:29], v[60:61]
    v_pk_mul_f32 v[30:31], v[30:31], v[62:63]
    v_cvt_pk_bf16_f32 v28, v28, v29
    v_cvt_pk_bf16_f32 v29, v30, v31
    buffer_store_dwordx2 v[28:29], v4, s[32:35], s43 offen sc1
    s_add_u32 s43, s22, 1
    s_and_b32 s44, s43, 1
    s_lshl_b32 s44, s44, 9
    s_lshr_b32 s43, s43, 1
    s_add_u32 s43, s43, 16
    s_mul_i32 s45, s18, 176
    s_add_u32 s43, s43, s45
    s_lshl_b32 s43, s43, 10
    s_add_u32 s43, s43, s44
    s_add_u32 s43, s43, 14680064
    v_lshlrev_b32 v64, 16, v184
    v_and_b32 v65, 0xffff0000, v184
    v_lshlrev_b32 v66, 16, v185
    v_and_b32 v67, 0xffff0000, v185
    v_lshlrev_b32 v68, 16, v186
    v_and_b32 v69, 0xffff0000, v186
    v_lshlrev_b32 v70, 16, v187
    v_and_b32 v71, 0xffff0000, v187
    v_pk_mul_f32 v[112:113], v[64:65], v[64:65]
    v_pk_mul_f32 v[114:115], v[66:67], v[66:67]
    v_pk_mul_f32 v[116:117], v[68:69], v[68:69]
    v_pk_mul_f32 v[118:119], v[70:71], v[70:71]
    v_pk_fma_f32 v[112:113], v[112:113], v[208:209], v[206:207]
    v_pk_fma_f32 v[114:115], v[114:115], v[208:209], v[206:207]
    v_pk_fma_f32 v[116:117], v[116:117], v[208:209], v[206:207]
    v_pk_fma_f32 v[118:119], v[118:119], v[208:209], v[206:207]
    v_pk_mul_f32 v[112:113], v[112:113], v[64:65]
    v_pk_mul_f32 v[114:115], v[114:115], v[66:67]
    v_pk_mul_f32 v[116:117], v[116:117], v[68:69]
    v_pk_mul_f32 v[118:119], v[118:119], v[70:71]
    v_exp_f32 v112, v112
    v_exp_f32 v113, v113
    v_exp_f32 v114, v114
    v_exp_f32 v115, v115
    v_exp_f32 v116, v116
    v_exp_f32 v117, v117
    v_exp_f32 v118, v118
    v_exp_f32 v119, v119
    v_pk_add_f32 v[112:113], v[112:113], v[210:211]
    v_pk_add_f32 v[114:115], v[114:115], v[210:211]
    v_pk_add_f32 v[116:117], v[116:117], v[210:211]
    v_pk_add_f32 v[118:119], v[118:119], v[210:211]
    v_rcp_f32 v112, v112
    v_rcp_f32 v113, v113
    v_rcp_f32 v114, v114
    v_rcp_f32 v115, v115
    v_rcp_f32 v116, v116
    v_rcp_f32 v117, v117
    v_rcp_f32 v118, v118
    v_rcp_f32 v119, v119
    v_pk_mul_f32 v[64:65], v[64:65], v[112:113]
    v_pk_mul_f32 v[66:67], v[66:67], v[114:115]
    v_pk_mul_f32 v[68:69], v[68:69], v[116:117]
    v_pk_mul_f32 v[70:71], v[70:71], v[118:119]
    v_pk_add_f32 v[32:33], v[32:33], v[192:193] op_sel:[0,0] op_sel_hi:[1,0]
    v_pk_mul_f32 v[64:65], v[64:65], v[196:197] op_sel:[0,0] op_sel_hi:[1,0]
    v_pk_add_f32 v[34:35], v[34:35], v[192:193] op_sel:[0,0] op_sel_hi:[1,0]
    v_pk_mul_f32 v[66:67], v[66:67], v[196:197] op_sel:[0,0] op_sel_hi:[1,0]
    v_pk_mul_f32 v[32:33], v[32:33], v[64:65]
    v_pk_mul_f32 v[34:35], v[34:35], v[66:67]
    v_cvt_pk_bf16_f32 v32, v32, v33
    v_cvt_pk_bf16_f32 v33, v34, v35
    buffer_store_dwordx2 v[32:33], v4, s[32:35], s43 offen sc1
    s_add_u32 s43, s43, 45056
    v_pk_add_f32 v[36:37], v[36:37], v[192:193] op_sel:[0,1] op_sel_hi:[1,1]
    v_pk_mul_f32 v[68:69], v[68:69], v[196:197] op_sel:[0,1] op_sel_hi:[1,1]
    v_pk_add_f32 v[38:39], v[38:39], v[192:193] op_sel:[0,1] op_sel_hi:[1,1]
    v_pk_mul_f32 v[70:71], v[70:71], v[196:197] op_sel:[0,1] op_sel_hi:[1,1]
    v_pk_mul_f32 v[36:37], v[36:37], v[68:69]
    v_pk_mul_f32 v[38:39], v[38:39], v[70:71]
    v_cvt_pk_bf16_f32 v36, v36, v37
    v_cvt_pk_bf16_f32 v37, v38, v39
    buffer_store_dwordx2 v[36:37], v4, s[32:35], s43 offen sc1
    s_add_u32 s43, s43, 45056
    v_lshlrev_b32 v72, 16, v188
    v_and_b32 v73, 0xffff0000, v188
    v_lshlrev_b32 v74, 16, v189
    v_and_b32 v75, 0xffff0000, v189
    v_lshlrev_b32 v76, 16, v190
    v_and_b32 v77, 0xffff0000, v190
    v_lshlrev_b32 v78, 16, v191
    v_and_b32 v79, 0xffff0000, v191
    v_pk_mul_f32 v[112:113], v[72:73], v[72:73]
    v_pk_mul_f32 v[114:115], v[74:75], v[74:75]
    v_pk_mul_f32 v[116:117], v[76:77], v[76:77]
    v_pk_mul_f32 v[118:119], v[78:79], v[78:79]
    v_pk_fma_f32 v[112:113], v[112:113], v[208:209], v[206:207]
    v_pk_fma_f32 v[114:115], v[114:115], v[208:209], v[206:207]
    v_pk_fma_f32 v[116:117], v[116:117], v[208:209], v[206:207]
    v_pk_fma_f32 v[118:119], v[118:119], v[208:209], v[206:207]
    v_pk_mul_f32 v[112:113], v[112:113], v[72:73]
    v_pk_mul_f32 v[114:115], v[114:115], v[74:75]
    v_pk_mul_f32 v[116:117], v[116:117], v[76:77]
    v_pk_mul_f32 v[118:119], v[118:119], v[78:79]
    v_exp_f32 v112, v112
    v_exp_f32 v113, v113
    v_exp_f32 v114, v114
    v_exp_f32 v115, v115
    v_exp_f32 v116, v116
    v_exp_f32 v117, v117
    v_exp_f32 v118, v118
    v_exp_f32 v119, v119
    v_pk_add_f32 v[112:113], v[112:113], v[210:211]
    v_pk_add_f32 v[114:115], v[114:115], v[210:211]
    v_pk_add_f32 v[116:117], v[116:117], v[210:211]
    v_pk_add_f32 v[118:119], v[118:119], v[210:211]
    v_rcp_f32 v112, v112
    v_rcp_f32 v113, v113
    v_rcp_f32 v114, v114
    v_rcp_f32 v115, v115
    v_rcp_f32 v116, v116
    v_rcp_f32 v117, v117
    v_rcp_f32 v118, v118
    v_rcp_f32 v119, v119
    v_pk_mul_f32 v[72:73], v[72:73], v[112:113]
    v_pk_mul_f32 v[74:75], v[74:75], v[114:115]
    v_pk_mul_f32 v[76:77], v[76:77], v[116:117]
    v_pk_mul_f32 v[78:79], v[78:79], v[118:119]
    v_pk_add_f32 v[40:41], v[40:41], v[194:195] op_sel:[0,0] op_sel_hi:[1,0]
    v_pk_mul_f32 v[72:73], v[72:73], v[198:199] op_sel:[0,0] op_sel_hi:[1,0]
    v_pk_add_f32 v[42:43], v[42:43], v[194:195] op_sel:[0,0] op_sel_hi:[1,0]
    v_pk_mul_f32 v[74:75], v[74:75], v[198:199] op_sel:[0,0] op_sel_hi:[1,0]
    v_pk_mul_f32 v[40:41], v[40:41], v[72:73]
    v_pk_mul_f32 v[42:43], v[42:43], v[74:75]
    v_cvt_pk_bf16_f32 v40, v40, v41
    v_cvt_pk_bf16_f32 v41, v42, v43
    buffer_store_dwordx2 v[40:41], v4, s[32:35], s43 offen sc1
    s_add_u32 s43, s43, 45056
    v_pk_add_f32 v[44:45], v[44:45], v[194:195] op_sel:[0,1] op_sel_hi:[1,1]
    v_pk_mul_f32 v[76:77], v[76:77], v[198:199] op_sel:[0,1] op_sel_hi:[1,1]
    v_pk_add_f32 v[46:47], v[46:47], v[194:195] op_sel:[0,1] op_sel_hi:[1,1]
    v_pk_mul_f32 v[78:79], v[78:79], v[198:199] op_sel:[0,1] op_sel_hi:[1,1]
    v_pk_mul_f32 v[44:45], v[44:45], v[76:77]
    v_pk_mul_f32 v[46:47], v[46:47], v[78:79]
    v_cvt_pk_bf16_f32 v44, v44, v45
    v_cvt_pk_bf16_f32 v45, v46, v47
    buffer_store_dwordx2 v[44:45], v4, s[32:35], s43 offen sc1
    s_waitcnt vmcnt(0)
    s_barrier
    s_cmp_eq_u32 s20, 0
    s_cbranch_scc0 K2_fg_2
    s_lshl_b32 s43, s18, 3
    s_add_u32 s43, s43, s19
    s_lshl_b32 s43, s43, 2
    s_add_u32 s43, s43, 21562368
    v_mov_b32 v4, 0
    v_mov_b32 v5, 1
    s_mov_b64 s[52:53], exec
    s_mov_b64 exec, 1
    buffer_store_dword v5, v4, s[32:35], s43 offen sc1
    s_mov_b64 exec, s[52:53]
K2_fg_2:
    s_branch K2_fin
K2_gw3:
    s_mov_b32 s45, s21
    s_mov_b32 s46, s21
    s_lshl_b32 s43, s45, 7
    s_add_u32 s45, s45, 1
    s_and_b32 s45, s45, 31
    s_add_u32 m0, s47, 0
    s_nop 0
    buffer_load_dwordx4 v202, s[24:27], s43 offen offset:0  lds
    buffer_load_dwordx4 v203, s[24:27], s43 offen offset:1024  lds
    s_lshl_b32 s43, s45, 7
    s_add_u32 s45, s45, 1
    s_and_b32 s45, s45, 31
    s_add_u32 m0, s47, 8192
    s_nop 0
    buffer_load_dwordx4 v202, s[24:27], s43 offen offset:0  lds
    buffer_load_dwordx4 v203, s[24:27], s43 offen offset:1024  lds
    s_lshl_b32 s44, s46, 11
    s_add_u32 s44, s44, s48
    s_add_u32 s46, s46, 1
    s_and_b32 s46, s46, 31
    buffer_load_dwordx4 v[112:115], v204, s[32:35], s44 offen offset:0
    buffer_load_dwordx4 v[116:119], v204, s[32:35], s44 offen offset:1024
    s_lshl_b32 s43, s45, 7
    s_add_u32 s45, s45, 1
    s_and_b32 s45, s45, 31
    s_add_u32 m0, s47, 16384
    s_nop 0
    buffer_load_dwordx4 v202, s[24:27], s43 offen offset:0  lds
    buffer_load_dwordx4 v203, s[24:27], s43 offen offset:1024  lds
    s_lshl_b32 s44, s46, 11
    s_add_u32 s44, s44, s48
    s_add_u32 s46, s46, 1
    s_and_b32 s46, s46, 31
    buffer_load_dwordx4 v[128:131], v204, s[32:35], s44 offen offset:0
    buffer_load_dwordx4 v[132:135], v204, s[32:35], s44 offen offset:1024
    s_lshl_b32 s43, s45, 7
    s_add_u32 s45, s45, 1
    s_and_b32 s45, s45, 31
    s_add_u32 m0, s47, 24576
    s_nop 0
    buffer_load_dwordx4 v202, s[24:27], s43 offen offset:0  lds
    buffer_load_dwordx4 v203, s[24:27], s43 offen offset:1024  lds
    s_lshl_b32 s44, s46, 11
    s_add_u32 s44, s44, s48
    s_add_u32 s46, s46, 1
    s_and_b32 s46, s46, 31
    buffer_load_dwordx4 v[144:147], v204, s[32:35], s44 offen offset:0
    buffer_load_dwordx4 v[148:151], v204, s[32:35], s44 offen offset:1024
    v_mov_b32 v16, 0
    v_mov_b32 v17, 0
    v_mov_b32 v18, 0
    v_mov_b32 v19, 0
    v_mov_b32 v20, 0
    v_mov_b32 v21, 0
    v_mov_b32 v22, 0
    v_mov_b32 v23, 0
    v_mov_b32 v24, 0
    v_mov_b32 v25, 0
    v_mov_b32 v26, 0
    v_mov_b32 v27, 0
    v_mov_b32 v28, 0
    v_mov_b32 v29, 0
    v_mov_b32 v30, 0
    v_mov_b32 v31, 0
    v_lshrrev_b32 v4, 1, v2
    v_xor_b32 v4, v4, v3
    v_lshlrev_b32 v5, 7, v2
    v_lshl_add_u32 v200, v4, 4, v5
    v_xor_b32 v201, 64, v200
    v_mov_b32 v206, 0xc0135761
    v_mov_b32 v207, 0xc0135761
    v_mov_b32 v208, 0xbdd2d3e8
    v_mov_b32 v209, 0xbdd2d3e8
    v_mov_b32 v210, 1.0
    v_mov_b32 v211, 1.0
    s_waitcnt vmcnt(12)
    s_barrier
    ds_read_b128 v[48:51], v200 offset:0
    ds_read_b128 v[52:55], v200 offset:2048
    ds_read_b128 v[56:59], v200 offset:4096
    ds_read_b128 v[60:63], v200 offset:6144
    ds_read_b128 v[64:67], v201 offset:0
    ds_read_b128 v[68:71], v201 offset:2048
    ds_read_b128 v[72:75], v201 offset:4096
    ds_read_b128 v[76:79], v201 offset:6144
    s_mov_b32 s40, 0
    s_lshl_b32 s43, s45, 7
    s_add_u32 s45, s45, 1
    s_and_b32 s45, s45, 31
    s_add_u32 m0, s47, 0
    s_lshl_b32 s44, s46, 11
    s_add_u32 s44, s44, s48
    s_add_u32 s46, s46, 1
    s_and_b32 s46, s46, 31
.p2align 6
K2_gloop_1:
    s_waitcnt vmcnt(8) lgkmcnt(0)
    s_barrier
    buffer_load_dwordx4 v202, s[24:27], s43 offen offset:0  lds
    v_mfma_f32_16x16x32_bf16 v[16:19], v[112:115], v[48:51], v[16:19]
    ds_read_b128 v[80:83], v200 offset:8192
    ds_read_b128 v[84:87], v200 offset:10240
    v_mfma_f32_16x16x32_bf16 v[20:23], v[112:115], v[52:55], v[20:23]
    ds_read_b128 v[88:91], v200 offset:12288
    ds_read_b128 v[92:95], v200 offset:14336
    buffer_load_dwordx4 v203, s[24:27], s43 offen offset:1024  lds
    v_mfma_f32_16x16x32_bf16 v[24:27], v[112:115], v[56:59], v[24:27]
    ds_read_b128 v[96:99], v201 offset:8192
    ds_read_b128 v[100:103], v201 offset:10240
    v_mfma_f32_16x16x32_bf16 v[28:31], v[112:115], v[60:63], v[28:31]
    ds_read_b128 v[104:107], v201 offset:12288
    ds_read_b128 v[108:111], v201 offset:14336
    v_mfma_f32_16x16x32_bf16 v[16:19], v[116:119], v[64:67], v[16:19]
    s_lshl_b32 s53, s45, 7
    s_add_u32 s45, s45, 1
    buffer_load_dwordx4 v[160:163], v204, s[32:35], s44 offen offset:0
    v_mfma_f32_16x16x32_bf16 v[20:23], v[116:119], v[68:71], v[20:23]
    s_and_b32 s45, s45, 31
    s_lshl_b32 s54, s46, 11
    v_mfma_f32_16x16x32_bf16 v[24:27], v[116:119], v[72:75], v[24:27]
    s_add_u32 s54, s54, s48
    s_add_u32 s46, s46, 1
    v_mfma_f32_16x16x32_bf16 v[28:31], v[116:119], v[76:79], v[28:31]
    s_and_b32 s46, s46, 31
    s_add_u32 m0, s47, 8192
    buffer_load_dwordx4 v[164:167], v204, s[32:35], s44 offen offset:1024
    s_waitcnt vmcnt(8) lgkmcnt(0)
    s_barrier
    buffer_load_dwordx4 v202, s[24:27], s53 offen offset:0  lds
    v_mfma_f32_16x16x32_bf16 v[16:19], v[128:131], v[80:83], v[16:19]
    ds_read_b128 v[48:51], v200 offset:16384
    ds_read_b128 v[52:55], v200 offset:18432
    v_mfma_f32_16x16x32_bf16 v[20:23], v[128:131], v[84:87], v[20:23]
    ds_read_b128 v[56:59], v200 offset:20480
    ds_read_b128 v[60:63], v200 offset:22528
    buffer_load_dwordx4 v203, s[24:27], s53 offen offset:1024  lds
    v_mfma_f32_16x16x32_bf16 v[24:27], v[128:131], v[88:91], v[24:27]
    ds_read_b128 v[64:67], v201 offset:16384
    ds_read_b128 v[68:71], v201 offset:18432
    v_mfma_f32_16x16x32_bf16 v[28:31], v[128:131], v[92:95], v[28:31]
    ds_read_b128 v[72:75], v201 offset:20480
    ds_read_b128 v[76:79], v201 offset:22528
    v_mfma_f32_16x16x32_bf16 v[16:19], v[132:135], v[96:99], v[16:19]
    s_lshl_b32 s43, s45, 7
    s_add_u32 s45, s45, 1
    buffer_load_dwordx4 v[112:115], v204, s[32:35], s54 offen offset:0
    v_mfma_f32_16x16x32_bf16 v[20:23], v[132:135], v[100:103], v[20:23]
    s_and_b32 s45, s45, 31
    s_lshl_b32 s44, s46, 11
    v_mfma_f32_16x16x32_bf16 v[24:27], v[132:135], v[104:107], v[24:27]
    s_add_u32 s44, s44, s48
    s_add_u32 s46, s46, 1
    v_mfma_f32_16x16x32_bf16 v[28:31], v[132:135], v[108:111], v[28:31]
    s_and_b32 s46, s46, 31
    s_add_u32 m0, s47, 16384
    buffer_load_dwordx4 v[116:119], v204, s[32:35], s54 offen offset:1024
    s_waitcnt vmcnt(8) lgkmcnt(0)
    s_barrier
    buffer_load_dwordx4 v202, s[24:27], s43 offen offset:0  lds
    v_mfma_f32_16x16x32_bf16 v[16:19], v[144:147], v[48:51], v[16:19]
    ds_read_b128 v[80:83], v200 offset:24576
    ds_read_b128 v[84:87], v200 offset:26624
    v_mfma_f32_16x16x32_bf16 v[20:23], v[144:147], v[52:55], v[20:23]
    ds_read_b128 v[88:91], v200 offset:28672
    ds_read_b128 v[92:95], v200 offset:30720
    buffer_load_dwordx4 v203, s[24:27], s43 offen offset:1024  lds
    v_mfma_f32_16x16x32_bf16 v[24:27], v[144:147], v[56:59], v[24:27]
    ds_read_b128 v[96:99], v201 offset:24576
    ds_read_b128 v[100:103], v201 offset:26624
    v_mfma_f32_16x16x32_bf16 v[28:31], v[144:147], v[60:63], v[28:31]
    ds_read_b128 v[104:107], v201 offset:28672
    ds_read_b128 v[108:111], v201 offset:30720
    v_mfma_f32_16x16x32_bf16 v[16:19], v[148:151], v[64:67], v[16:19]
    s_lshl_b32 s53, s45, 7
    s_add_u32 s45, s45, 1
    buffer_load_dwordx4 v[128:131], v204, s[32:35], s44 offen offset:0
    v_mfma_f32_16x16x32_bf16 v[20:23], v[148:151], v[68:71], v[20:23]
    s_and_b32 s45, s45, 31
    s_lshl_b32 s54, s46, 11
    v_mfma_f32_16x16x32_bf16 v[24:27], v[148:151], v[72:75], v[24:27]
    s_add_u32 s54, s54, s48
    s_add_u32 s46, s46, 1
    v_mfma_f32_16x16x32_bf16 v[28:31], v[148:151], v[76:79], v[28:31]
    s_and_b32 s46, s46, 31
    s_add_u32 m0, s47, 24576
    buffer_load_dwordx4 v[132:135], v204, s[32:35], s44 offen offset:1024
    s_waitcnt vmcnt(8) lgkmcnt(0)
    s_barrier
    buffer_load_dwordx4 v202, s[24:27], s53 offen offset:0  lds
    v_mfma_f32_16x16x32_bf16 v[16:19], v[160:163], v[80:83], v[16:19]
    ds_read_b128 v[48:51], v200 offset:0
    ds_read_b128 v[52:55], v200 offset:2048
    ds_read_b128 v[56:59], v200 offset:4096
    v_mfma_f32_16x16x32_bf16 v[20:23], v[160:163], v[84:87], v[20:23]
    ds_read_b128 v[60:63], v200 offset:6144
    ds_read_b128 v[64:67], v201 offset:0
    buffer_load_dwordx4 v203, s[24:27], s53 offen offset:1024  lds
    v_mfma_f32_16x16x32_bf16 v[24:27], v[160:163], v[88:91], v[24:27]
    ds_read_b128 v[68:71], v201 offset:2048
    ds_read_b128 v[72:75], v201 offset:4096
    v_mfma_f32_16x16x32_bf16 v[28:31], v[160:163], v[92:95], v[28:31]
    ds_read_b128 v[76:79], v201 offset:6144
    s_add_u32 s40, s40, 1
    v_mfma_f32_16x16x32_bf16 v[16:19], v[164:167], v[96:99], v[16:19]
    s_lshl_b32 s43, s45, 7
    s_add_u32 s45, s45, 1
    s_and_b32 s45, s45, 31
    buffer_load_dwordx4 v[144:147], v204, s[32:35], s54 offen offset:0
    v_mfma_f32_16x16x32_bf16 v[20:23], v[164:167], v[100:103], v[20:23]
    s_lshl_b32 s44, s46, 11
    s_add_u32 s44, s44, s48
    v_mfma_f32_16x16x32_bf16 v[24:27], v[164:167], v[104:107], v[24:27]
    s_add_u32 s46, s46, 1
    s_and_b32 s46, s46, 31
    v_mfma_f32_16x16x32_bf16 v[28:31], v[164:167], v[108:111], v[28:31]
    s_add_u32 m0, s47, 0
    s_cmp_lt_u32 s40, 6
    buffer_load_dwordx4 v[148:151], v204, s[32:35], s54 offen offset:1024
    s_cbranch_scc1 K2_gloop_1
K2_gtail_1:
    s_waitcnt vmcnt(8) lgkmcnt(0)
    s_barrier
    buffer_load_dwordx4 v202, s[24:27], s43 offen offset:0  lds
    v_mfma_f32_16x16x32_bf16 v[16:19], v[112:115], v[48:51], v[16:19]
    ds_read_b128 v[80:83], v200 offset:8192
    ds_read_b128 v[84:87], v200 offset:10240
    v_mfma_f32_16x16x32_bf16 v[20:23], v[112:115], v[52:55], v[20:23]
    ds_read_b128 v[88:91], v200 offset:12288
    ds_read_b128 v[92:95], v200 offset:14336
    buffer_load_dwordx4 v203, s[24:27], s43 offen offset:1024  lds
    v_mfma_f32_16x16x32_bf16 v[24:27], v[112:115], v[56:59], v[24:27]
    ds_read_b128 v[96:99], v201 offset:8192
    ds_read_b128 v[100:103], v201 offset:10240
    v_mfma_f32_16x16x32_bf16 v[28:31], v[112:115], v[60:63], v[28:31]
    ds_read_b128 v[104:107], v201 offset:12288
    ds_read_b128 v[108:111], v201 offset:14336
    v_mfma_f32_16x16x32_bf16 v[16:19], v[116:119], v[64:67], v[16:19]
    s_lshl_b32 s53, s45, 7
    s_add_u32 s45, s45, 1
    buffer_load_dwordx4 v[160:163], v204, s[32:35], s44 offen offset:0
    v_mfma_f32_16x16x32_bf16 v[20:23], v[116:119], v[68:71], v[20:23]
    s_and_b32 s45, s45, 31
    s_lshl_b32 s54, s46, 11
    v_mfma_f32_16x16x32_bf16 v[24:27], v[116:119], v[72:75], v[24:27]
    s_add_u32 s54, s54, s48
    s_add_u32 s46, s46, 1
    v_mfma_f32_16x16x32_bf16 v[28:31], v[116:119], v[76:79], v[28:31]
    s_and_b32 s46, s46, 31
    s_add_u32 m0, s47, 8192
    buffer_load_dwordx4 v[164:167], v204, s[32:35], s44 offen offset:1024
    s_waitcnt vmcnt(8) lgkmcnt(0)
    s_barrier
    buffer_load_dwordx4 v202, s[24:27], s53 offen offset:0  lds
    v_mfma_f32_16x16x32_bf16 v[16:19], v[128:131], v[80:83], v[16:19]
    ds_read_b128 v[48:51], v200 offset:16384
    ds_read_b128 v[52:55], v200 offset:18432
    v_mfma_f32_16x16x32_bf16 v[20:23], v[128:131], v[84:87], v[20:23]
    ds_read_b128 v[56:59], v200 offset:20480
    ds_read_b128 v[60:63], v200 offset:22528
    buffer_load_dwordx4 v203, s[24:27], s53 offen offset:1024  lds
    v_mfma_f32_16x16x32_bf16 v[24:27], v[128:131], v[88:91], v[24:27]
    ds_read_b128 v[64:67], v201 offset:16384
    ds_read_b128 v[68:71], v201 offset:18432
    v_mfma_f32_16x16x32_bf16 v[28:31], v[128:131], v[92:95], v[28:31]
    ds_read_b128 v[72:75], v201 offset:20480
    ds_read_b128 v[76:79], v201 offset:22528
    v_mfma_f32_16x16x32_bf16 v[16:19], v[132:135], v[96:99], v[16:19]
    s_lshl_b32 s43, s45, 7
    s_add_u32 s45, s45, 1
    buffer_load_dwordx4 v[112:115], v204, s[32:35], s54 offen offset:0
    v_mfma_f32_16x16x32_bf16 v[20:23], v[132:135], v[100:103], v[20:23]
    s_and_b32 s45, s45, 31
    s_lshl_b32 s44, s46, 11
    v_mfma_f32_16x16x32_bf16 v[24:27], v[132:135], v[104:107], v[24:27]
    s_add_u32 s44, s44, s48
    s_add_u32 s46, s46, 1
    v_mfma_f32_16x16x32_bf16 v[28:31], v[132:135], v[108:111], v[28:31]
    s_and_b32 s46, s46, 31
    s_add_u32 m0, s47, 16384
    buffer_load_dwordx4 v[116:119], v204, s[32:35], s54 offen offset:1024
    s_waitcnt vmcnt(8) lgkmcnt(0)
    s_barrier
    buffer_load_dwordx4 v202, s[24:27], s43 offen offset:0  lds
    v_mfma_f32_16x16x32_bf16 v[16:19], v[144:147], v[48:51], v[16:19]
    ds_read_b128 v[80:83], v200 offset:24576
    ds_read_b128 v[84:87], v200 offset:26624
    v_mfma_f32_16x16x32_bf16 v[20:23], v[144:147], v[52:55], v[20:23]
    ds_read_b128 v[88:91], v200 offset:28672
    ds_read_b128 v[92:95], v200 offset:30720
    buffer_load_dwordx4 v203, s[24:27], s43 offen offset:1024  lds
    v_mfma_f32_16x16x32_bf16 v[24:27], v[144:147], v[56:59], v[24:27]
    ds_read_b128 v[96:99], v201 offset:24576
    ds_read_b128 v[100:103], v201 offset:26624
    v_mfma_f32_16x16x32_bf16 v[28:31], v[144:147], v[60:63], v[28:31]
    ds_read_b128 v[104:107], v201 offset:28672
    ds_read_b128 v[108:111], v201 offset:30720
    v_mfma_f32_16x16x32_bf16 v[16:19], v[148:151], v[64:67], v[16:19]
    s_lshl_b32 s53, s45, 7
    s_add_u32 s45, s45, 1
    buffer_load_dwordx4 v[128:131], v204, s[32:35], s44 offen offset:0
    v_mfma_f32_16x16x32_bf16 v[20:23], v[148:151], v[68:71], v[20:23]
    s_and_b32 s45, s45, 31
    s_lshl_b32 s54, s46, 11
    v_mfma_f32_16x16x32_bf16 v[24:27], v[148:151], v[72:75], v[24:27]
    s_add_u32 s54, s54, s48
    s_add_u32 s46, s46, 1
    v_mfma_f32_16x16x32_bf16 v[28:31], v[148:151], v[76:79], v[28:31]
    s_and_b32 s46, s46, 31
    s_add_u32 m0, s47, 24576
    buffer_load_dwordx4 v[132:135], v204, s[32:35], s44 offen offset:1024
    s_waitcnt vmcnt(8) lgkmcnt(0)
    s_barrier
    buffer_load_dwordx4 v202, s[24:27], s53 offen offset:0  lds
    v_mfma_f32_16x16x32_bf16 v[16:19], v[160:163], v[80:83], v[16:19]
    ds_read_b128 v[48:51], v200 offset:0
    ds_read_b128 v[52:55], v200 offset:2048
    v_mfma_f32_16x16x32_bf16 v[20:23], v[160:163], v[84:87], v[20:23]
    ds_read_b128 v[56:59], v200 offset:4096
    buffer_load_dwordx4 v203, s[24:27], s53 offen offset:1024  lds
    v_mfma_f32_16x16x32_bf16 v[24:27], v[160:163], v[88:91], v[24:27]
    ds_read_b128 v[60:63], v200 offset:6144
    ds_read_b128 v[64:67], v201 offset:0
    v_mfma_f32_16x16x32_bf16 v[28:31], v[160:163], v[92:95], v[28:31]
    ds_read_b128 v[68:71], v201 offset:2048
    v_mfma_f32_16x16x32_bf16 v[16:19], v[164:167], v[96:99], v[16:19]
    ds_read_b128 v[72:75], v201 offset:4096
    ds_read_b128 v[76:79], v201 offset:6144
    buffer_load_dwordx4 v[144:147], v204, s[32:35], s54 offen offset:0
    v_mfma_f32_16x16x32_bf16 v[20:23], v[164:167], v[100:103], v[20:23]
    s_lshl_b32 s44, s46, 11
    v_mfma_f32_16x16x32_bf16 v[24:27], v[164:167], v[104:107], v[24:27]
    s_add_u32 s44, s44, s48
    s_add_u32 s46, s46, 1
    v_mfma_f32_16x16x32_bf16 v[28:31], v[164:167], v[108:111], v[28:31]
    s_and_b32 s46, s46, 31
    buffer_load_dwordx4 v[148:151], v204, s[32:35], s54 offen offset:1024
    s_waitcnt vmcnt(8) lgkmcnt(0)
    s_barrier
    buffer_load_dwordx4 v[160:163], v204, s[32:35], s44 offen offset:0
    v_mfma_f32_16x16x32_bf16 v[16:19], v[112:115], v[48:51], v[16:19]
    ds_read_b128 v[80:83], v200 offset:8192
    v_mfma_f32_16x16x32_bf16 v[20:23], v[112:115], v[52:55], v[20:23]
    ds_read_b128 v[84:87], v200 offset:10240
    v_mfma_f32_16x16x32_bf16 v[24:27], v[112:115], v[56:59], v[24:27]
    ds_read_b128 v[88:91], v200 offset:12288
    v_mfma_f32_16x16x32_bf16 v[28:31], v[112:115], v[60:63], v[28:31]
    ds_read_b128 v[92:95], v200 offset:14336
    v_mfma_f32_16x16x32_bf16 v[16:19], v[116:119], v[64:67], v[16:19]
    ds_read_b128 v[96:99], v201 offset:8192
    v_mfma_f32_16x16x32_bf16 v[20:23], v[116:119], v[68:71], v[20:23]
    ds_read_b128 v[100:103], v201 offset:10240
    v_mfma_f32_16x16x32_bf16 v[24:27], v[116:119], v[72:75], v[24:27]
    ds_read_b128 v[104:107], v201 offset:12288
    v_mfma_f32_16x16x32_bf16 v[28:31], v[116:119], v[76:79], v[28:31]
    ds_read_b128 v[108:111], v201 offset:14336
    buffer_load_dwordx4 v[164:167], v204, s[32:35], s44 offen offset:1024
    v_lshlrev_b32 v4, 4, v1
    s_lshl_b32 s43, s18, 1
    s_mul_i32 s43, s43, 56
    s_add_u32 s43, s43, s22
    s_lshl_b32 s43, s43, 10
    s_add_u32 s43, s43, 6291456
    buffer_load_dwordx4 v[176:179], v4, s[32:35], s43 offen offset:0
    s_add_u32 s43, s43, 57344
    buffer_load_dwordx4 v[180:183], v4, s[32:35], s43 offen offset:0
    s_lshl_b32 s43, s18, 6
    v_add_u32 v5, s43, v2
    v_lshlrev_b32 v6, 1, v5
    v_lshlrev_b32 v7, 2, v5
    s_mov_b32 s44, 21495808
    buffer_load_ushort v192, v6, s[28:31], 0 offen offset:0
    buffer_load_dword v196, v7, s[32:35], s44 offen offset:0
    buffer_load_ushort v193, v6, s[28:31], 0 offen offset:32
    buffer_load_dword v197, v7, s[32:35], s44 offen offset:64
    buffer_load_ushort v194, v6, s[28:31], 0 offen offset:64
    buffer_load_dword v198, v7, s[32:35], s44 offen offset:128
    buffer_load_ushort v195, v6, s[28:31], 0 offen offset:96
    buffer_load_dword v199, v7, s[32:35], s44 offen offset:192
    s_waitcnt vmcnt(16) lgkmcnt(0)
    s_barrier
    v_mfma_f32_16x16x32_bf16 v[16:19], v[128:131], v[80:83], v[16:19]
    ds_read_b128 v[48:51], v200 offset:16384
    v_mfma_f32_16x16x32_bf16 v[20:23], v[128:131], v[84:87], v[20:23]
    ds_read_b128 v[52:55], v200 offset:18432
    v_mfma_f32_16x16x32_bf16 v[24:27], v[128:131], v[88:91], v[24:27]
    ds_read_b128 v[56:59], v200 offset:20480
    v_mfma_f32_16x16x32_bf16 v[28:31], v[128:131], v[92:95], v[28:31]
    ds_read_b128 v[60:63], v200 offset:22528
    v_mfma_f32_16x16x32_bf16 v[16:19], v[132:135], v[96:99], v[16:19]
    ds_read_b128 v[64:67], v201 offset:16384
    v_mfma_f32_16x16x32_bf16 v[20:23], v[132:135], v[100:103], v[20:23]
    ds_read_b128 v[68:71], v201 offset:18432
    v_mfma_f32_16x16x32_bf16 v[24:27], v[132:135], v[104:107], v[24:27]
    ds_read_b128 v[72:75], v201 offset:20480
    v_mfma_f32_16x16x32_bf16 v[28:31], v[132:135], v[108:111], v[28:31]
    ds_read_b128 v[76:79], v201 offset:22528
    s_waitcnt vmcnt(12) lgkmcnt(0)
    s_barrier
    v_mfma_f32_16x16x32_bf16 v[16:19], v[144:147], v[48:51], v[16:19]
    ds_read_b128 v[80:83], v200 offset:24576
    v_mfma_f32_16x16x32_bf16 v[20:23], v[144:147], v[52:55], v[20:23]
    ds_read_b128 v[84:87], v200 offset:26624
    v_mfma_f32_16x16x32_bf16 v[24:27], v[144:147], v[56:59], v[24:27]
    ds_read_b128 v[88:91], v200 offset:28672
    v_mfma_f32_16x16x32_bf16 v[28:31], v[144:147], v[60:63], v[28:31]
    ds_read_b128 v[92:95], v200 offset:30720
    v_mfma_f32_16x16x32_bf16 v[16:19], v[148:151], v[64:67], v[16:19]
    ds_read_b128 v[96:99], v201 offset:24576
    v_mfma_f32_16x16x32_bf16 v[20:23], v[148:151], v[68:71], v[20:23]
    ds_read_b128 v[100:103], v201 offset:26624
    v_mfma_f32_16x16x32_bf16 v[24:27], v[148:151], v[72:75], v[24:27]
    ds_read_b128 v[104:107], v201 offset:28672
    v_mfma_f32_16x16x32_bf16 v[28:31], v[148:151], v[76:79], v[28:31]
    ds_read_b128 v[108:111], v201 offset:30720
    s_waitcnt vmcnt(10) lgkmcnt(0)
    s_barrier
    v_mfma_f32_16x16x32_bf16 v[16:19], v[160:163], v[80:83], v[16:19]
    v_mfma_f32_16x16x32_bf16 v[20:23], v[160:163], v[84:87], v[20:23]
    v_mfma_f32_16x16x32_bf16 v[24:27], v[160:163], v[88:91], v[24:27]
    v_mfma_f32_16x16x32_bf16 v[28:31], v[160:163], v[92:95], v[28:31]
    v_mfma_f32_16x16x32_bf16 v[16:19], v[164:167], v[96:99], v[16:19]
    v_mfma_f32_16x16x32_bf16 v[20:23], v[164:167], v[100:103], v[20:23]
    v_mfma_f32_16x16x32_bf16 v[24:27], v[164:167], v[104:107], v[24:27]
    v_mfma_f32_16x16x32_bf16 v[28:31], v[164:167], v[108:111], v[28:31]
    s_waitcnt vmcnt(0)
    v_lshlrev_b32 v4, 4, v2
    v_lshrrev_b32 v5, 1, v3
    v_lshl_add_u32 v4, v5, 8, v4
    v_and_b32 v5, 1, v3
    v_lshl_add_u32 v4, v5, 3, v4
    v_sub_f32 v196, 1.0, v196
    v_lshlrev_b32 v192, 16, v192
    v_sub_f32 v197, 1.0, v197
    v_lshlrev_b32 v193, 16, v193
    v_sub_f32 v198, 1.0, v198
    v_lshlrev_b32 v194, 16, v194
    v_sub_f32 v199, 1.0, v199
    v_lshlrev_b32 v195, 16, v195
    s_add_u32 s43, s22, 0
    s_and_b32 s44, s43, 1
    s_lshl_b32 s44, s44, 9
    s_lshr_b32 s43, s43, 1
    s_add_u32 s43, s43, 16
    s_mul_i32 s45, s18, 176
    s_add_u32 s43, s43, s45
    s_lshl_b32 s43, s43, 10
    s_add_u32 s43, s43, s44
    s_add_u32 s43, s43, 14680064
    v_lshlrev_b32 v48, 16, v176
    v_and_b32 v49, 0xffff0000, v176
    v_lshlrev_b32 v50, 16, v177
    v_and_b32 v51, 0xffff0000, v177
    v_lshlrev_b32 v52, 16, v178
    v_and_b32 v53, 0xffff0000, v178
    v_lshlrev_b32 v54, 16, v179
    v_and_b32 v55, 0xffff0000, v179
    v_pk_mul_f32 v[112:113], v[48:49], v[48:49]
    v_pk_mul_f32 v[114:115], v[50:51], v[50:51]
    v_pk_mul_f32 v[116:117], v[52:53], v[52:53]
    v_pk_mul_f32 v[118:119], v[54:55], v[54:55]
    v_pk_fma_f32 v[112:113], v[112:113], v[208:209], v[206:207]
    v_pk_fma_f32 v[114:115], v[114:115], v[208:209], v[206:207]
    v_pk_fma_f32 v[116:117], v[116:117], v[208:209], v[206:207]
    v_pk_fma_f32 v[118:119], v[118:119], v[208:209], v[206:207]
    v_pk_mul_f32 v[112:113], v[112:113], v[48:49]
    v_pk_mul_f32 v[114:115], v[114:115], v[50:51]
    v_pk_mul_f32 v[116:117], v[116:117], v[52:53]
    v_pk_mul_f32 v[118:119], v[118:119], v[54:55]
    v_exp_f32 v112, v112
    v_exp_f32 v113, v113
    v_exp_f32 v114, v114
    v_exp_f32 v115, v115
    v_exp_f32 v116, v116
    v_exp_f32 v117, v117
    v_exp_f32 v118, v118
    v_exp_f32 v119, v119
    v_pk_add_f32 v[112:113], v[112:113], v[210:211]
    v_pk_add_f32 v[114:115], v[114:115], v[210:211]
    v_pk_add_f32 v[116:117], v[116:117], v[210:211]
    v_pk_add_f32 v[118:119], v[118:119], v[210:211]
    v_rcp_f32 v112, v112
    v_rcp_f32 v113, v113
    v_rcp_f32 v114, v114
    v_rcp_f32 v115, v115
    v_rcp_f32 v116, v116
    v_rcp_f32 v117, v117
    v_rcp_f32 v118, v118
    v_rcp_f32 v119, v119
    v_pk_mul_f32 v[48:49], v[48:49], v[112:113]
    v_pk_mul_f32 v[50:51], v[50:51], v[114:115]
    v_pk_mul_f32 v[52:53], v[52:53], v[116:117]
    v_pk_mul_f32 v[54:55], v[54:55], v[118:119]
    v_pk_add_f32 v[16:17], v[16:17], v[192:193] op_sel:[0,0] op_sel_hi:[1,0]
    v_pk_mul_f32 v[48:49], v[48:49], v[196:197] op_sel:[0,0] op_sel_hi:[1,0]
    v_pk_add_f32 v[18:19], v[18:19], v[192:193] op_sel:[0,0] op_sel_hi:[1,0]
    v_pk_mul_f32 v[50:51], v[50:51], v[196:197] op_sel:[0,0] op_sel_hi:[1,0]
    v_pk_mul_f32 v[16:17], v[16:17], v[48:49]
    v_pk_mul_f32 v[18:19], v[18:19], v[50:51]
    v_cvt_pk_bf16_f32 v16, v16, v17
    v_cvt_pk_bf16_f32 v17, v18, v19
    buffer_store_dwordx2 v[16:17], v4, s[32:35], s43 offen sc1
    s_add_u32 s43, s43, 45056
    v_pk_add_f32 v[20:21], v[20:21], v[192:193] op_sel:[0,1] op_sel_hi:[1,1]
    v_pk_mul_f32 v[52:53], v[52:53], v[196:197] op_sel:[0,1] op_sel_hi:[1,1]
    v_pk_add_f32 v[22:23], v[22:23], v[192:193] op_sel:[0,1] op_sel_hi:[1,1]
    v_pk_mul_f32 v[54:55], v[54:55], v[196:197] op_sel:[0,1] op_sel_hi:[1,1]
    v_pk_mul_f32 v[20:21], v[20:21], v[52:53]
    v_pk_mul_f32 v[22:23], v[22:23], v[54:55]
    v_cvt_pk_bf16_f32 v20, v20, v21
    v_cvt_pk_bf16_f32 v21, v22, v23
    buffer_store_dwordx2 v[20:21], v4, s[32:35], s43 offen sc1
    s_add_u32 s43, s43, 45056
    v_lshlrev_b32 v56, 16, v180
    v_and_b32 v57, 0xffff0000, v180
    v_lshlrev_b32 v58, 16, v181
    v_and_b32 v59, 0xffff0000, v181
    v_lshlrev_b32 v60, 16, v182
    v_and_b32 v61, 0xffff0000, v182
    v_lshlrev_b32 v62, 16, v183
    v_and_b32 v63, 0xffff0000, v183
    v_pk_mul_f32 v[112:113], v[56:57], v[56:57]
    v_pk_mul_f32 v[114:115], v[58:59], v[58:59]
    v_pk_mul_f32 v[116:117], v[60:61], v[60:61]
    v_pk_mul_f32 v[118:119], v[62:63], v[62:63]
    v_pk_fma_f32 v[112:113], v[112:113], v[208:209], v[206:207]
    v_pk_fma_f32 v[114:115], v[114:115], v[208:209], v[206:207]
    v_pk_fma_f32 v[116:117], v[116:117], v[208:209], v[206:207]
    v_pk_fma_f32 v[118:119], v[118:119], v[208:209], v[206:207]
    v_pk_mul_f32 v[112:113], v[112:113], v[56:57]
    v_pk_mul_f32 v[114:115], v[114:115], v[58:59]
    v_pk_mul_f32 v[116:117], v[116:117], v[60:61]
    v_pk_mul_f32 v[118:119], v[118:119], v[62:63]
    v_exp_f32 v112, v112
    v_exp_f32 v113, v113
    v_exp_f32 v114, v114
    v_exp_f32 v115, v115
    v_exp_f32 v116, v116
    v_exp_f32 v117, v117
    v_exp_f32 v118, v118
    v_exp_f32 v119, v119
    v_pk_add_f32 v[112:113], v[112:113], v[210:211]
    v_pk_add_f32 v[114:115], v[114:115], v[210:211]
    v_pk_add_f32 v[116:117], v[116:117], v[210:211]
    v_pk_add_f32 v[118:119], v[118:119], v[210:211]
    v_rcp_f32 v112, v112
    v_rcp_f32 v113, v113
    v_rcp_f32 v114, v114
    v_rcp_f32 v115, v115
    v_rcp_f32 v116, v116
    v_rcp_f32 v117, v117
    v_rcp_f32 v118, v118
    v_rcp_f32 v119, v119
    v_pk_mul_f32 v[56:57], v[56:57], v[112:113]
    v_pk_mul_f32 v[58:59], v[58:59], v[114:115]
    v_pk_mul_f32 v[60:61], v[60:61], v[116:117]
    v_pk_mul_f32 v[62:63], v[62:63], v[118:119]
    v_pk_add_f32 v[24:25], v[24:25], v[194:195] op_sel:[0,0] op_sel_hi:[1,0]
    v_pk_mul_f32 v[56:57], v[56:57], v[198:199] op_sel:[0,0] op_sel_hi:[1,0]
    v_pk_add_f32 v[26:27], v[26:27], v[194:195] op_sel:[0,0] op_sel_hi:[1,0]
    v_pk_mul_f32 v[58:59], v[58:59], v[198:199] op_sel:[0,0] op_sel_hi:[1,0]
    v_pk_mul_f32 v[24:25], v[24:25], v[56:57]
    v_pk_mul_f32 v[26:27], v[26:27], v[58:59]
    v_cvt_pk_bf16_f32 v24, v24, v25
    v_cvt_pk_bf16_f32 v25, v26, v27
    buffer_store_dwordx2 v[24:25], v4, s[32:35], s43 offen sc1
    s_add_u32 s43, s43, 45056
    v_pk_add_f32 v[28:29], v[28:29], v[194:195] op_sel:[0,1] op_sel_hi:[1,1]
    v_pk_mul_f32 v[60:61], v[60:61], v[198:199] op_sel:[0,1] op_sel_hi:[1,1]
    v_pk_add_f32 v[30:31], v[30:31], v[194:195] op_sel:[0,1] op_sel_hi:[1,1]
    v_pk_mul_f32 v[62:63], v[62:63], v[198:199] op_sel:[0,1] op_sel_hi:[1,1]
    v_pk_mul_f32 v[28:29], v[28:29], v[60:61]
    v_pk_mul_f32 v[30:31], v[30:31], v[62:63]
    v_cvt_pk_bf16_f32 v28, v28, v29
    v_cvt_pk_bf16_f32 v29, v30, v31
    buffer_store_dwordx2 v[28:29], v4, s[32:35], s43 offen sc1
    s_waitcnt vmcnt(0)
    s_barrier
    s_cmp_eq_u32 s20, 0
    s_cbranch_scc0 K2_fg_1
    s_lshl_b32 s43, s18, 3
    s_add_u32 s43, s43, s19
    s_lshl_b32 s43, s43, 2
    s_add_u32 s43, s43, 21562368
    v_mov_b32 v4, 0
    v_mov_b32 v5, 1
    s_mov_b64 s[52:53], exec
    s_mov_b64 exec, 1
    buffer_store_dword v5, v4, s[32:35], s43 offen sc1
    s_mov_b64 exec, s[52:53]
K2_fg_1:
    s_branch K2_fin
K2_attn:
    s_sub_u32 s17, s2, 256
    s_and_b32 s14, s17, 7
    s_lshr_b32 s15, s17, 3
    s_lshr_b32 s16, s15, 2
    s_and_b32 s17, s15, 3
    s_lshl_b32 s43, s14, 2
    s_add_u32 s17, s17, s43
    s_waitcnt lgkmcnt(0)
    s_lshl_b32 s43, s17, 16
    s_add_u32 s43, s43, 0
    s_add_u32 s24, s10, s43
    s_addc_u32 s25, s11, 0
    s_mov_b32 s26, 65536
    s_mov_b32 s27, 0x20000
    s_add_u32 s43, s43, 2097152
    s_add_u32 s28, s10, s43
    s_addc_u32 s29, s11, 0
    s_mov_b32 s30, 65536
    s_mov_b32 s31, 0x20000
    s_add_u32 s43, s43, 2097152
    s_add_u32 s36, s10, s43
    s_addc_u32 s37, s11, 0
    s_mov_b32 s38, 65536
    s_mov_b32 s39, 0x20000
    s_mov_b32 s32, s10
    s_mov_b32 s33, s11
    s_mov_b32 s34, 22020096
    s_mov_b32 s35, 0x20000
    v_lshlrev_b32 v2, 4, v1
    s_lshl_b32 s43, s16, 13
    s_sub_u32 s43, s43, 8192
    s_lshl_b32 s44, s20, 12
    s_add_u32 s43, s43, s44
    s_add_u32 m0, s44, 0
    s_add_u32 s45, s43, 0
    buffer_load_dwordx4 v2, s[28:31], s45 offen  lds
    s_add_u32 m0, s44, 16384
    s_nop 0
    buffer_load_dwordx4 v2, s[36:39], s45 offen  lds
    s_add_u32 m0, s44, 1024
    s_add_u32 s45, s43, 1024
    buffer_load_dwordx4 v2, s[28:31], s45 offen  lds
    s_add_u32 m0, s44, 17408
    s_nop 0
    buffer_load_dwordx4 v2, s[36:39], s45 offen  lds
    s_add_u32 m0, s44, 2048
    s_add_u32 s45, s43, 2048
    buffer_load_dwordx4 v2, s[28:31], s45 offen  lds
    s_add_u32 m0, s44, 18432
    s_nop 0
    buffer_load_dwordx4 v2, s[36:39], s45 offen  lds
    s_add_u32 m0, s44, 3072
    s_add_u32 s45, s43, 3072
    buffer_load_dwordx4 v2, s[28:31], s45 offen  lds
    s_add_u32 m0, s44, 19456
    s_nop 0
    buffer_load_dwordx4 v2, s[36:39], s45 offen  lds
    v_and_b32 v3, 31, v1
    v_lshrrev_b32 v4, 5, v1
    s_lshl_b32 s43, s16, 8
    s_lshl_b32 s44, s20, 6
    s_add_u32 s43, s43, s44
    v_add_u32 v5, s43, v3
    v_lshlrev_b32 v6, 5, v5
    v_lshl_add_u32 v6, v4, 4, v6
    buffer_load_dwordx4 v[236:239], v6, s[24:27], 0 offen
    buffer_load_dwordx4 v[240:243], v6, s[24:27], 0 offen offset:1024
    v_lshlrev_b32 v6, 2, v5
    s_mov_b32 s44, 21495808
    buffer_load_dword v247, v6, s[32:35], s44 offen
    buffer_load_dword v248, v6, s[32:35], s44 offen offset:128
    s_setprio 0
    v_mov_b32 v8, 0x3f803f80
    v_mov_b32 v9, 0x3f803f80
    v_lshlrev_b32 v6, 3, v1
    ds_write_b64 v6, v[8:9] offset:32768
    v_lshlrev_b32 v6, 2, v4
    v_sub_u32 v6, v3, v6
    v_mov_b32 v7, 0xff800000
    v_mov_b32 v8, 0
    v_cmp_le_i32 s[52:53], 0, v6
    s_nop 1
    v_cndmask_b32 v176, v7, v8, s[52:53]
    v_cndmask_b32 v192, v8, v7, s[52:53]
    v_cmp_le_i32 s[52:53], 1, v6
    s_nop 1
    v_cndmask_b32 v177, v7, v8, s[52:53]
    v_cndmask_b32 v193, v8, v7, s[52:53]
    v_cmp_le_i32 s[52:53], 2, v6
    s_nop 1
    v_cndmask_b32 v178, v7, v8, s[52:53]
    v_cndmask_b32 v194, v8, v7, s[52:53]
    v_cmp_le_i32 s[52:53], 3, v6
    s_nop 1
    v_cndmask_b32 v179, v7, v8, s[52:53]
    v_cndmask_b32 v195, v8, v7, s[52:53]
    v_cmp_le_i32 s[52:53], 8, v6
    s_nop 1
    v_cndmask_b32 v180, v7, v8, s[52:53]
    v_cndmask_b32 v196, v8, v7, s[52:53]
    v_cmp_le_i32 s[52:53], 9, v6
    s_nop 1
    v_cndmask_b32 v181, v7, v8, s[52:53]
    v_cndmask_b32 v197, v8, v7, s[52:53]
    v_cmp_le_i32 s[52:53], 10, v6
    s_nop 1
    v_cndmask_b32 v182, v7, v8, s[52:53]
    v_cndmask_b32 v198, v8, v7, s[52:53]
    v_cmp_le_i32 s[52:53], 11, v6
    s_nop 1
    v_cndmask_b32 v183, v7, v8, s[52:53]
    v_cndmask_b32 v199, v8, v7, s[52:53]
    v_cmp_le_i32 s[52:53], 16, v6
    s_nop 1
    v_cndmask_b32 v184, v7, v8, s[52:53]
    v_cndmask_b32 v200, v8, v7, s[52:53]
    v_cmp_le_i32 s[52:53], 17, v6
    s_nop 1
    v_cndmask_b32 v185, v7, v8, s[52:53]
    v_cndmask_b32 v201, v8, v7, s[52:53]
    v_cmp_le_i32 s[52:53], 18, v6
    s_nop 1
    v_cndmask_b32 v186, v7, v8, s[52:53]
    v_cndmask_b32 v202, v8, v7, s[52:53]
    v_cmp_le_i32 s[52:53], 19, v6
    s_nop 1
    v_cndmask_b32 v187, v7, v8, s[52:53]
    v_cndmask_b32 v203, v8, v7, s[52:53]
    v_cmp_le_i32 s[52:53], 24, v6
    s_nop 1
    v_cndmask_b32 v188, v7, v8, s[52:53]
    v_cndmask_b32 v204, v8, v7, s[52:53]
    v_cmp_le_i32 s[52:53], 25, v6
    s_nop 1
    v_cndmask_b32 v189, v7, v8, s[52:53]
    v_cndmask_b32 v205, v8, v7, s[52:53]
    v_cmp_le_i32 s[52:53], 26, v6
    s_nop 1
    v_cndmask_b32 v190, v7, v8, s[52:53]
    v_cndmask_b32 v206, v8, v7, s[52:53]
    v_cmp_le_i32 s[52:53], 27, v6
    s_nop 1
    v_cndmask_b32 v191, v7, v8, s[52:53]
    v_cndmask_b32 v207, v8, v7, s[52:53]
    v_lshlrev_b32 v6, 5, v3
    v_lshl_add_u32 v6, v4, 4, v6
    s_lshl_b32 s43, s20, 11
    v_add_u32 v244, s43, v6
    v_and_b32 v6, 15, v1
    v_lshlrev_b32 v6, 3, v6
    v_lshl_add_u32 v7, v4, 7, v6
    s_add_u32 s43, s43, 16384
    v_add_u32 v7, s43, v7
    v_add_u32 v6, 32768, v6
    v_and_b32 v8, 16, v1
    v_cmp_eq_u32 s[52:53], 0, v8
    s_nop 1
    v_cndmask_b32 v245, v6, v7, s[52:53]
    v_mov_b32 v6, 0
    v_mov_b32 v7, 512
    v_cndmask_b32 v246, v6, v7, s[52:53]
    s_lshl_b32 s43, s16, 4
    s_lshl_b32 s44, s20, 2
    s_add_u32 s43, s43, s44
    v_lshrrev_b32 v6, 4, v3
    v_add_u32 v6, s43, v6
    v_mul_u32_u24 v6, 44, v6
    s_lshr_b32 s44, s17, 1
    v_add_u32 v6, s44, v6
    v_lshlrev_b32 v6, 10, v6
    v_and_b32 v7, 15, v3
    v_lshl_add_u32 v6, v7, 4, v6
    s_and_b32 s44, s17, 1
    s_lshl_b32 s44, s44, 9
    v_add_u32 v6, s44, v6
    v_lshl_add_u32 v10, v4, 3, v6
    s_waitcnt vmcnt(0) lgkmcnt(0)
    s_barrier
    s_setprio 0
    s_mov_b32 s40, 0
.p2align 6
K2_aloop:
    s_cmp_eq_u32 s40, 0
    s_cselect_b64 s[52:53], -1, 0
    v_cndmask_b32 v12, v240, v236, s[52:53]
    v_cndmask_b32 v13, v241, v237, s[52:53]
    v_cndmask_b32 v14, v242, v238, s[52:53]
    v_cndmask_b32 v15, v243, v239, s[52:53]
    v_cndmask_b32 v11, v248, v247, s[52:53]
    ds_read_b128 v[96:99], v244 offset:0
    ds_read_b128 v[100:103], v244 offset:1024
    ds_read_b128 v[104:107], v244 offset:2048
    ds_read_b128 v[108:111], v244 offset:3072
    ds_read_b128 v[112:115], v244 offset:4096
    ds_read_b128 v[116:119], v244 offset:5120
    ds_read_b128 v[120:123], v244 offset:6144
    ds_read_b128 v[124:127], v244 offset:7168
    ds_read_b128 v[128:131], v244 offset:8192
    v_mov_b32 v253, v245
    s_lshl_b32 s43, s20, 1
    s_add_u32 s43, s43, s40
    s_sub_u32 s43, 8, s43
    s_cmp_eq_u32 s16, 0
    s_cselect_b32 s46, s43, 0
    s_waitcnt lgkmcnt(7)
    v_mfma_f32_32x32x16_bf16 v[16:31], v[96:99], v[12:15], v[192:207]
    v_mfma_f32_32x32x16_bf16 v[32:47], v[100:103], v[12:15], 0
    ds_read_b64_tr_b16 v[220:221], v245
    ds_read_b64_tr_b16 v[222:223], v245 offset:256
    v_add_u32 v245, v246, v245
    ds_read_b64_tr_b16 v[224:225], v245
    ds_read_b64_tr_b16 v[226:227], v245 offset:256
    v_add_u32 v245, v246, v245
    s_waitcnt lgkmcnt(4)
    v_mfma_f32_32x32x16_bf16 v[48:63], v[104:107], v[12:15], 0
    ds_read_b64_tr_b16 v[228:229], v245
    ds_read_b64_tr_b16 v[230:231], v245 offset:256
    v_add_u32 v245, v246, v245
    ds_read_b64_tr_b16 v[232:233], v245
    ds_read_b64_tr_b16 v[234:235], v245 offset:256
    v_add_u32 v245, v246, v245
    s_cmp_gt_u32 s46, 0
    s_cbranch_scc1 K2_fz0
    v_exp_f32 v16, v16
    v_exp_f32 v17, v17
    v_exp_f32 v18, v18
    v_exp_f32 v19, v19
    v_exp_f32 v20, v20
    v_exp_f32 v21, v21
    v_exp_f32 v22, v22
    v_exp_f32 v23, v23
    v_exp_f32 v24, v24
    v_exp_f32 v25, v25
    v_exp_f32 v26, v26
    v_exp_f32 v27, v27
    v_exp_f32 v28, v28
    v_exp_f32 v29, v29
    v_exp_f32 v30, v30
    v_exp_f32 v31, v31
    v_cvt_pk_bf16_f32 v16, v16, v17
    v_cvt_pk_bf16_f32 v17, v18, v19
    v_cvt_pk_bf16_f32 v18, v20, v21
    v_cvt_pk_bf16_f32 v19, v22, v23
    v_cvt_pk_bf16_f32 v20, v24, v25
    v_cvt_pk_bf16_f32 v21, v26, v27
    v_cvt_pk_bf16_f32 v22, v28, v29
    v_cvt_pk_bf16_f32 v23, v30, v31
K2_fb0:
    s_waitcnt lgkmcnt(4)
    v_mfma_f32_32x32x16_bf16 v[160:175], v[220:223], v[16:19], 0
    v_mfma_f32_32x32x16_bf16 v[64:79], v[108:111], v[12:15], 0
    v_mfma_f32_32x32x16_bf16 v[160:175], v[224:227], v[20:23], v[160:175]
    ds_read_b64_tr_b16 v[220:221], v245
    ds_read_b64_tr_b16 v[222:223], v245 offset:256
    v_add_u32 v245, v246, v245
    ds_read_b64_tr_b16 v[224:225], v245
    ds_read_b64_tr_b16 v[226:227], v245 offset:256
    v_add_u32 v245, v246, v245
    s_cmp_gt_u32 s46, 1
    s_cbranch_scc1 K2_fz1
    v_exp_f32 v32, v32
    v_exp_f32 v33, v33
    v_exp_f32 v34, v34
    v_exp_f32 v35, v35
    v_exp_f32 v36, v36
    v_exp_f32 v37, v37
    v_exp_f32 v38, v38
    v_exp_f32 v39, v39
    v_exp_f32 v40, v40
    v_exp_f32 v41, v41
    v_exp_f32 v42, v42
    v_exp_f32 v43, v43
    v_exp_f32 v44, v44
    v_exp_f32 v45, v45
    v_exp_f32 v46, v46
    v_exp_f32 v47, v47
    v_cvt_pk_bf16_f32 v32, v32, v33
    v_cvt_pk_bf16_f32 v33, v34, v35
    v_cvt_pk_bf16_f32 v34, v36, v37
    v_cvt_pk_bf16_f32 v35, v38, v39
    v_cvt_pk_bf16_f32 v36, v40, v41
    v_cvt_pk_bf16_f32 v37, v42, v43
    v_cvt_pk_bf16_f32 v38, v44, v45
    v_cvt_pk_bf16_f32 v39, v46, v47
K2_fb1:
    s_waitcnt lgkmcnt(4)
    v_mfma_f32_32x32x16_bf16 v[160:175], v[228:231], v[32:35], v[160:175]
    v_mfma_f32_32x32x16_bf16 v[16:31], v[112:115], v[12:15], 0
    v_mfma_f32_32x32x16_bf16 v[160:175], v[232:235], v[36:39], v[160:175]
    ds_read_b64_tr_b16 v[228:229], v245
    ds_read_b64_tr_b16 v[230:231], v245 offset:256
    v_add_u32 v245, v246, v245
    ds_read_b64_tr_b16 v[232:233], v245
    ds_read_b64_tr_b16 v[234:235], v245 offset:256
    v_add_u32 v245, v246, v245
    s_cmp_gt_u32 s46, 2
    s_cbranch_scc1 K2_fz2
    v_exp_f32 v48, v48
    v_exp_f32 v49, v49
    v_exp_f32 v50, v50
    v_exp_f32 v51, v51
    v_exp_f32 v52, v52
    v_exp_f32 v53, v53
    v_exp_f32 v54, v54
    v_exp_f32 v55, v55
    v_exp_f32 v56, v56
    v_exp_f32 v57, v57
    v_exp_f32 v58, v58
    v_exp_f32 v59, v59
    v_exp_f32 v60, v60
    v_exp_f32 v61, v61
    v_exp_f32 v62, v62
    v_exp_f32 v63, v63
    v_cvt_pk_bf16_f32 v48, v48, v49
    v_cvt_pk_bf16_f32 v49, v50, v51
    v_cvt_pk_bf16_f32 v50, v52, v53
    v_cvt_pk_bf16_f32 v51, v54, v55
    v_cvt_pk_bf16_f32 v52, v56, v57
    v_cvt_pk_bf16_f32 v53, v58, v59
    v_cvt_pk_bf16_f32 v54, v60, v61
    v_cvt_pk_bf16_f32 v55, v62, v63
K2_fb2:
    s_waitcnt lgkmcnt(4)
    v_mfma_f32_32x32x16_bf16 v[160:175], v[220:223], v[48:51], v[160:175]
    v_mfma_f32_32x32x16_bf16 v[32:47], v[116:119], v[12:15], 0
    v_mfma_f32_32x32x16_bf16 v[160:175], v[224:227], v[52:55], v[160:175]
    ds_read_b64_tr_b16 v[220:221], v245
    ds_read_b64_tr_b16 v[222:223], v245 offset:256
    v_add_u32 v245, v246, v245
    ds_read_b64_tr_b16 v[224:225], v245
    ds_read_b64_tr_b16 v[226:227], v245 offset:256
    v_add_u32 v245, v246, v245
    s_cmp_gt_u32 s46, 3
    s_cbranch_scc1 K2_fz3
    v_exp_f32 v64, v64
    v_exp_f32 v65, v65
    v_exp_f32 v66, v66
    v_exp_f32 v67, v67
    v_exp_f32 v68, v68
    v_exp_f32 v69, v69
    v_exp_f32 v70, v70
    v_exp_f32 v71, v71
    v_exp_f32 v72, v72
    v_exp_f32 v73, v73
    v_exp_f32 v74, v74
    v_exp_f32 v75, v75
    v_exp_f32 v76, v76
    v_exp_f32 v77, v77
    v_exp_f32 v78, v78
    v_exp_f32 v79, v79
    v_cvt_pk_bf16_f32 v64, v64, v65
    v_cvt_pk_bf16_f32 v65, v66, v67
    v_cvt_pk_bf16_f32 v66, v68, v69
    v_cvt_pk_bf16_f32 v67, v70, v71
    v_cvt_pk_bf16_f32 v68, v72, v73
    v_cvt_pk_bf16_f32 v69, v74, v75
    v_cvt_pk_bf16_f32 v70, v76, v77
    v_cvt_pk_bf16_f32 v71, v78, v79
K2_fb3:
    s_waitcnt lgkmcnt(4)
    v_mfma_f32_32x32x16_bf16 v[160:175], v[228:231], v[64:67], v[160:175]
    v_mfma_f32_32x32x16_bf16 v[48:63], v[120:123], v[12:15], 0
    v_mfma_f32_32x32x16_bf16 v[160:175], v[232:235], v[68:71], v[160:175]
    ds_read_b64_tr_b16 v[228:229], v245
    ds_read_b64_tr_b16 v[230:231], v245 offset:256
    v_add_u32 v245, v246, v245
    ds_read_b64_tr_b16 v[232:233], v245
    ds_read_b64_tr_b16 v[234:235], v245 offset:256
    v_add_u32 v245, v246, v245
    s_cmp_gt_u32 s46, 4
    s_cbranch_scc1 K2_fz4
    v_exp_f32 v16, v16
    v_exp_f32 v17, v17
    v_exp_f32 v18, v18
    v_exp_f32 v19, v19
    v_exp_f32 v20, v20
    v_exp_f32 v21, v21
    v_exp_f32 v22, v22
    v_exp_f32 v23, v23
    v_exp_f32 v24, v24
    v_exp_f32 v25, v25
    v_exp_f32 v26, v26
    v_exp_f32 v27, v27
    v_exp_f32 v28, v28
    v_exp_f32 v29, v29
    v_exp_f32 v30, v30
    v_exp_f32 v31, v31
    v_cvt_pk_bf16_f32 v16, v16, v17
    v_cvt_pk_bf16_f32 v17, v18, v19
    v_cvt_pk_bf16_f32 v18, v20, v21
    v_cvt_pk_bf16_f32 v19, v22, v23
    v_cvt_pk_bf16_f32 v20, v24, v25
    v_cvt_pk_bf16_f32 v21, v26, v27
    v_cvt_pk_bf16_f32 v22, v28, v29
    v_cvt_pk_bf16_f32 v23, v30, v31
K2_fb4:
    s_waitcnt lgkmcnt(4)
    v_mfma_f32_32x32x16_bf16 v[160:175], v[220:223], v[16:19], v[160:175]
    v_mfma_f32_32x32x16_bf16 v[64:79], v[124:127], v[12:15], 0
    v_mfma_f32_32x32x16_bf16 v[160:175], v[224:227], v[20:23], v[160:175]
    ds_read_b64_tr_b16 v[220:221], v245
    ds_read_b64_tr_b16 v[222:223], v245 offset:256
    v_add_u32 v245, v246, v245
    ds_read_b64_tr_b16 v[224:225], v245
    ds_read_b64_tr_b16 v[226:227], v245 offset:256
    v_add_u32 v245, v246, v245
    s_cmp_gt_u32 s46, 5
    s_cbranch_scc1 K2_fz5
    v_exp_f32 v32, v32
    v_exp_f32 v33, v33
    v_exp_f32 v34, v34
    v_exp_f32 v35, v35
    v_exp_f32 v36, v36
    v_exp_f32 v37, v37
    v_exp_f32 v38, v38
    v_exp_f32 v39, v39
    v_exp_f32 v40, v40
    v_exp_f32 v41, v41
    v_exp_f32 v42, v42
    v_exp_f32 v43, v43
    v_exp_f32 v44, v44
    v_exp_f32 v45, v45
    v_exp_f32 v46, v46
    v_exp_f32 v47, v47
    v_cvt_pk_bf16_f32 v32, v32, v33
    v_cvt_pk_bf16_f32 v33, v34, v35
    v_cvt_pk_bf16_f32 v34, v36, v37
    v_cvt_pk_bf16_f32 v35, v38, v39
    v_cvt_pk_bf16_f32 v36, v40, v41
    v_cvt_pk_bf16_f32 v37, v42, v43
    v_cvt_pk_bf16_f32 v38, v44, v45
    v_cvt_pk_bf16_f32 v39, v46, v47
K2_fb5:
    s_waitcnt lgkmcnt(4)
    v_mfma_f32_32x32x16_bf16 v[160:175], v[228:231], v[32:35], v[160:175]
    v_mfma_f32_32x32x16_bf16 v[16:31], v[128:131], v[12:15], v[176:191]
    v_mfma_f32_32x32x16_bf16 v[160:175], v[232:235], v[36:39], v[160:175]
    ds_read_b64_tr_b16 v[228:229], v245
    ds_read_b64_tr_b16 v[230:231], v245 offset:256
    v_add_u32 v245, v246, v245
    ds_read_b64_tr_b16 v[232:233], v245
    ds_read_b64_tr_b16 v[234:235], v245 offset:256
    v_add_u32 v245, v246, v245
    s_cmp_gt_u32 s46, 6
    s_cbranch_scc1 K2_fz6
    v_exp_f32 v48, v48
    v_exp_f32 v49, v49
    v_exp_f32 v50, v50
    v_exp_f32 v51, v51
    v_exp_f32 v52, v52
    v_exp_f32 v53, v53
    v_exp_f32 v54, v54
    v_exp_f32 v55, v55
    v_exp_f32 v56, v56
    v_exp_f32 v57, v57
    v_exp_f32 v58, v58
    v_exp_f32 v59, v59
    v_exp_f32 v60, v60
    v_exp_f32 v61, v61
    v_exp_f32 v62, v62
    v_exp_f32 v63, v63
    v_cvt_pk_bf16_f32 v48, v48, v49
    v_cvt_pk_bf16_f32 v49, v50, v51
    v_cvt_pk_bf16_f32 v50, v52, v53
    v_cvt_pk_bf16_f32 v51, v54, v55
    v_cvt_pk_bf16_f32 v52, v56, v57
    v_cvt_pk_bf16_f32 v53, v58, v59
    v_cvt_pk_bf16_f32 v54, v60, v61
    v_cvt_pk_bf16_f32 v55, v62, v63
K2_fb6:
    s_waitcnt lgkmcnt(4)
    v_mfma_f32_32x32x16_bf16 v[160:175], v[220:223], v[48:51], v[160:175]
    v_mfma_f32_32x32x16_bf16 v[160:175], v[224:227], v[52:55], v[160:175]
    ds_read_b64_tr_b16 v[220:221], v245
    ds_read_b64_tr_b16 v[222:223], v245 offset:256
    v_add_u32 v245, v246, v245
    ds_read_b64_tr_b16 v[224:225], v245
    ds_read_b64_tr_b16 v[226:227], v245 offset:256
    v_add_u32 v245, v246, v245
    s_cmp_gt_u32 s46, 7
    s_cbranch_scc1 K2_fz7
    v_exp_f32 v64, v64
    v_exp_f32 v65, v65
    v_exp_f32 v66, v66
    v_exp_f32 v67, v67
    v_exp_f32 v68, v68
    v_exp_f32 v69, v69
    v_exp_f32 v70, v70
    v_exp_f32 v71, v71
    v_exp_f32 v72, v72
    v_exp_f32 v73, v73
    v_exp_f32 v74, v74
    v_exp_f32 v75, v75
    v_exp_f32 v76, v76
    v_exp_f32 v77, v77
    v_exp_f32 v78, v78
    v_exp_f32 v79, v79
    v_cvt_pk_bf16_f32 v64, v64, v65
    v_cvt_pk_bf16_f32 v65, v66, v67
    v_cvt_pk_bf16_f32 v66, v68, v69
    v_cvt_pk_bf16_f32 v67, v70, v71
    v_cvt_pk_bf16_f32 v68, v72, v73
    v_cvt_pk_bf16_f32 v69, v74, v75
    v_cvt_pk_bf16_f32 v70, v76, v77
    v_cvt_pk_bf16_f32 v71, v78, v79
K2_fb7:
    s_waitcnt lgkmcnt(4)
    v_mfma_f32_32x32x16_bf16 v[160:175], v[228:231], v[64:67], v[160:175]
    v_mfma_f32_32x32x16_bf16 v[160:175], v[232:235], v[68:71], v[160:175]
    v_exp_f32 v16, v16
    v_exp_f32 v17, v17
    v_exp_f32 v18, v18
    v_exp_f32 v19, v19
    v_exp_f32 v20, v20
    v_exp_f32 v21, v21
    v_exp_f32 v22, v22
    v_exp_f32 v23, v23
    v_exp_f32 v24, v24
    v_exp_f32 v25, v25
    v_exp_f32 v26, v26
    v_exp_f32 v27, v27
    v_exp_f32 v28, v28
    v_exp_f32 v29, v29
    v_exp_f32 v30, v30
    v_exp_f32 v31, v31
    v_cvt_pk_bf16_f32 v16, v16, v17
    v_cvt_pk_bf16_f32 v17, v18, v19
    v_cvt_pk_bf16_f32 v18, v20, v21
    v_cvt_pk_bf16_f32 v19, v22, v23
    v_cvt_pk_bf16_f32 v20, v24, v25
    v_cvt_pk_bf16_f32 v21, v26, v27
    v_cvt_pk_bf16_f32 v22, v28, v29
    v_cvt_pk_bf16_f32 v23, v30, v31
    s_waitcnt lgkmcnt(0)
    v_mfma_f32_32x32x16_bf16 v[160:175], v[220:223], v[16:19], v[160:175]
    v_mfma_f32_32x32x16_bf16 v[160:175], v[224:227], v[20:23], v[160:175]
    v_mov_b32 v2, 0x5f800000
    s_nop 10
    v_cmp_lt_f32 vcc, 0x21800000, v168
    v_cmp_gt_f32 s[52:53], v2, v168
    s_nop 0
    s_and_b64 vcc, vcc, s[52:53]
    s_cmp_eq_u64 vcc, -1
    s_cbranch_scc1 K2_afin
    v_mov_b32 v245, v253
    s_branch K2_slow
K2_fz0:
    v_mov_b32 v16, 0
    v_mov_b32 v17, 0
    v_mov_b32 v18, 0
    v_mov_b32 v19, 0
    v_mov_b32 v20, 0
    v_mov_b32 v21, 0
    v_mov_b32 v22, 0
    v_mov_b32 v23, 0
    s_branch K2_fb0
K2_fz1:
    v_mov_b32 v32, 0
    v_mov_b32 v33, 0
    v_mov_b32 v34, 0
    v_mov_b32 v35, 0
    v_mov_b32 v36, 0
    v_mov_b32 v37, 0
    v_mov_b32 v38, 0
    v_mov_b32 v39, 0
    s_branch K2_fb1
K2_fz2:
    v_mov_b32 v48, 0
    v_mov_b32 v49, 0
    v_mov_b32 v50, 0
    v_mov_b32 v51, 0
    v_mov_b32 v52, 0
    v_mov_b32 v53, 0
    v_mov_b32 v54, 0
    v_mov_b32 v55, 0
    s_branch K2_fb2
K2_fz3:
    v_mov_b32 v64, 0
    v_mov_b32 v65, 0
    v_mov_b32 v66, 0
    v_mov_b32 v67, 0
    v_mov_b32 v68, 0
    v_mov_b32 v69, 0
    v_mov_b32 v70, 0
    v_mov_b32 v71, 0
    s_branch K2_fb3
K2_fz4:
    v_mov_b32 v16, 0
    v_mov_b32 v17, 0
    v_mov_b32 v18, 0
    v_mov_b32 v19, 0
    v_mov_b32 v20, 0
    v_mov_b32 v21, 0
    v_mov_b32 v22, 0
    v_mov_b32 v23, 0
    s_branch K2_fb4
K2_fz5:
    v_mov_b32 v32, 0
    v_mov_b32 v33, 0
    v_mov_b32 v34, 0
    v_mov_b32 v35, 0
    v_mov_b32 v36, 0
    v_mov_b32 v37, 0
    v_mov_b32 v38, 0
    v_mov_b32 v39, 0
    s_branch K2_fb5
K2_fz6:
    v_mov_b32 v48, 0
    v_mov_b32 v49, 0
    v_mov_b32 v50, 0
    v_mov_b32 v51, 0
    v_mov_b32 v52, 0
    v_mov_b32 v53, 0
    v_mov_b32 v54, 0
    v_mov_b32 v55, 0
    s_branch K2_fb6
K2_fz7:
    v_mov_b32 v64, 0
    v_mov_b32 v65, 0
    v_mov_b32 v66, 0
    v_mov_b32 v67, 0
    v_mov_b32 v68, 0
    v_mov_b32 v69, 0
    v_mov_b32 v70, 0
    v_mov_b32 v71, 0
    s_branch K2_fb7
K2_slow:
    s_waitcnt lgkmcnt(0)
    ds_read_b128 v[208:211], v244 offset:0
    ds_read_b128 v[212:215], v244 offset:1024
    ds_read_b128 v[216:219], v244 offset:2048
    ds_read_b128 v[160:163], v244 offset:3072
    ds_read_b128 v[164:167], v244 offset:4096
    ds_read_b128 v[168:171], v244 offset:5120
    ds_read_b128 v[172:175], v244 offset:6144
    ds_read_b128 v[228:231], v244 offset:7168
    ds_read_b128 v[232:235], v244 offset:8192
    s_cmp_eq_u32 s16, 0
    s_cbranch_scc1 K2_qk0
    s_waitcnt lgkmcnt(8)
    v_mfma_f32_32x32x16_bf16 v[16:31], v[208:211], v[12:15], v[192:207]
    s_waitcnt lgkmcnt(7)
    v_mfma_f32_32x32x16_bf16 v[32:47], v[212:215], v[12:15], 0
    s_waitcnt lgkmcnt(6)
    v_mfma_f32_32x32x16_bf16 v[48:63], v[216:219], v[12:15], 0
    s_nop 7
    v_max3_f32 v2, v16, v17, v18
    v_max3_f32 v3, v19, v20, v21
    v_max3_f32 v4, v22, v23, v24
    v_max3_f32 v5, v25, v26, v27
    v_max3_f32 v2, v2, v28, v29
    v_max3_f32 v3, v3, v30, v31
    s_waitcnt lgkmcnt(5)
    v_mfma_f32_32x32x16_bf16 v[64:79], v[160:163], v[12:15], 0
    v_max3_f32 v2, v2, v32, v33
    v_max3_f32 v3, v3, v34, v35
    v_max3_f32 v4, v4, v36, v37
    v_max3_f32 v5, v5, v38, v39
    v_max3_f32 v2, v2, v40, v41
    v_max3_f32 v3, v3, v42, v43
    v_max3_f32 v4, v4, v44, v45
    v_max3_f32 v5, v5, v46, v47
    s_waitcnt lgkmcnt(4)
    v_mfma_f32_32x32x16_bf16 v[80:95], v[164:167], v[12:15], 0
    v_max3_f32 v2, v2, v48, v49
    v_max3_f32 v3, v3, v50, v51
    v_max3_f32 v4, v4, v52, v53
    v_max3_f32 v5, v5, v54, v55
    v_max3_f32 v2, v2, v56, v57
    v_max3_f32 v3, v3, v58, v59
    v_max3_f32 v4, v4, v60, v61
    v_max3_f32 v5, v5, v62, v63
    s_waitcnt lgkmcnt(3)
    v_mfma_f32_32x32x16_bf16 v[96:111], v[168:171], v[12:15], 0
    v_max3_f32 v2, v2, v64, v65
    v_max3_f32 v3, v3, v66, v67
    v_max3_f32 v4, v4, v68, v69
    v_max3_f32 v5, v5, v70, v71
    v_max3_f32 v2, v2, v72, v73
    v_max3_f32 v3, v3, v74, v75
    v_max3_f32 v4, v4, v76, v77
    v_max3_f32 v5, v5, v78, v79
    s_waitcnt lgkmcnt(2)
    v_mfma_f32_32x32x16_bf16 v[112:127], v[172:175], v[12:15], 0
    v_max3_f32 v2, v2, v80, v81
    v_max3_f32 v3, v3, v82, v83
    v_max3_f32 v4, v4, v84, v85
    v_max3_f32 v5, v5, v86, v87
    v_max3_f32 v2, v2, v88, v89
    v_max3_f32 v3, v3, v90, v91
    v_max3_f32 v4, v4, v92, v93
    v_max3_f32 v5, v5, v94, v95
    s_waitcnt lgkmcnt(1)
    v_mfma_f32_32x32x16_bf16 v[128:143], v[228:231], v[12:15], 0
    v_max3_f32 v2, v2, v96, v97
    v_max3_f32 v3, v3, v98, v99
    v_max3_f32 v4, v4, v100, v101
    v_max3_f32 v5, v5, v102, v103
    v_max3_f32 v2, v2, v104, v105
    v_max3_f32 v3, v3, v106, v107
    v_max3_f32 v4, v4, v108, v109
    v_max3_f32 v5, v5, v110, v111
    s_waitcnt lgkmcnt(0)
    v_mfma_f32_32x32x16_bf16 v[144:159], v[232:235], v[12:15], v[176:191]
    v_max3_f32 v2, v2, v112, v113
    v_max3_f32 v3, v3, v114, v115
    v_max3_f32 v4, v4, v116, v117
    v_max3_f32 v5, v5, v118, v119
    v_max3_f32 v2, v2, v120, v121
    v_max3_f32 v3, v3, v122, v123
    v_max3_f32 v4, v4, v124, v125
    v_max3_f32 v5, v5, v126, v127
    ds_read_b64_tr_b16 v[220:221], v245
    ds_read_b64_tr_b16 v[222:223], v245 offset:256
    v_add_u32 v245, v246, v245
    ds_read_b64_tr_b16 v[224:225], v245
    ds_read_b64_tr_b16 v[226:227], v245 offset:256
    v_add_u32 v245, v246, v245
    v_max3_f32 v2, v2, v128, v129
    v_max3_f32 v3, v3, v130, v131
    v_max3_f32 v4, v4, v132, v133
    v_max3_f32 v5, v5, v134, v135
    v_max3_f32 v2, v2, v136, v137
    v_max3_f32 v3, v3, v138, v139
    v_max3_f32 v4, v4, v140, v141
    v_max3_f32 v5, v5, v142, v143
    v_max3_f32 v2, v2, v144, v145
    v_max3_f32 v3, v3, v146, v147
    v_max3_f32 v4, v4, v148, v149
    v_max3_f32 v5, v5, v150, v151
    v_max3_f32 v2, v2, v152, v153
    v_max3_f32 v3, v3, v154, v155
    v_max3_f32 v4, v4, v156, v157
    v_max3_f32 v5, v5, v158, v159
    s_branch K2_qkdone
K2_qk0:
    s_waitcnt lgkmcnt(8)
    v_mfma_f32_32x32x16_bf16 v[16:31], v[208:211], v[12:15], v[192:207]
    s_waitcnt lgkmcnt(7)
    v_mfma_f32_32x32x16_bf16 v[32:47], v[212:215], v[12:15], 0
    s_waitcnt lgkmcnt(6)
    v_mfma_f32_32x32x16_bf16 v[48:63], v[216:219], v[12:15], 0
    s_waitcnt lgkmcnt(5)
    v_mfma_f32_32x32x16_bf16 v[64:79], v[160:163], v[12:15], 0
    s_waitcnt lgkmcnt(4)
    v_mfma_f32_32x32x16_bf16 v[80:95], v[164:167], v[12:15], 0
    s_waitcnt lgkmcnt(3)
    v_mfma_f32_32x32x16_bf16 v[96:111], v[168:171], v[12:15], 0
    s_waitcnt lgkmcnt(2)
    v_mfma_f32_32x32x16_bf16 v[112:127], v[172:175], v[12:15], 0
    s_waitcnt lgkmcnt(1)
    v_mfma_f32_32x32x16_bf16 v[128:143], v[228:231], v[12:15], 0
    s_waitcnt lgkmcnt(0)
    v_mfma_f32_32x32x16_bf16 v[144:159], v[232:235], v[12:15], v[176:191]
    ds_read_b64_tr_b16 v[220:221], v245
    ds_read_b64_tr_b16 v[222:223], v245 offset:256
    v_add_u32 v245, v246, v245
    ds_read_b64_tr_b16 v[224:225], v245
    ds_read_b64_tr_b16 v[226:227], v245 offset:256
    v_add_u32 v245, v246, v245
    s_lshl_b32 s43, s20, 1
    s_add_u32 s43, s43, s40
    s_cmp_lt_u32 s43, 8
    s_cbranch_scc0 K2_fix0
    v_mov_b32 v16, 0xff800000
    v_mov_b32 v17, 0xff800000
    v_mov_b32 v18, 0xff800000
    v_mov_b32 v19, 0xff800000
    v_mov_b32 v20, 0xff800000
    v_mov_b32 v21, 0xff800000
    v_mov_b32 v22, 0xff800000
    v_mov_b32 v23, 0xff800000
    v_mov_b32 v24, 0xff800000
    v_mov_b32 v25, 0xff800000
    v_mov_b32 v26, 0xff800000
    v_mov_b32 v27, 0xff800000
    v_mov_b32 v28, 0xff800000
    v_mov_b32 v29, 0xff800000
    v_mov_b32 v30, 0xff800000
    v_mov_b32 v31, 0xff800000
K2_fix0:
    s_cmp_lt_u32 s43, 7
    s_cbranch_scc0 K2_fix1
    v_mov_b32 v32, 0xff800000
    v_mov_b32 v33, 0xff800000
    v_mov_b32 v34, 0xff800000
    v_mov_b32 v35, 0xff800000
    v_mov_b32 v36, 0xff800000
    v_mov_b32 v37, 0xff800000
    v_mov_b32 v38, 0xff800000
    v_mov_b32 v39, 0xff800000
    v_mov_b32 v40, 0xff800000
    v_mov_b32 v41, 0xff800000
    v_mov_b32 v42, 0xff800000
    v_mov_b32 v43, 0xff800000
    v_mov_b32 v44, 0xff800000
    v_mov_b32 v45, 0xff800000
    v_mov_b32 v46, 0xff800000
    v_mov_b32 v47, 0xff800000
K2_fix1:
    s_cmp_lt_u32 s43, 6
    s_cbranch_scc0 K2_fix2
    v_mov_b32 v48, 0xff800000
    v_mov_b32 v49, 0xff800000
    v_mov_b32 v50, 0xff800000
    v_mov_b32 v51, 0xff800000
    v_mov_b32 v52, 0xff800000
    v_mov_b32 v53, 0xff800000
    v_mov_b32 v54, 0xff800000
    v_mov_b32 v55, 0xff800000
    v_mov_b32 v56, 0xff800000
    v_mov_b32 v57, 0xff800000
    v_mov_b32 v58, 0xff800000
    v_mov_b32 v59, 0xff800000
    v_mov_b32 v60, 0xff800000
    v_mov_b32 v61, 0xff800000
    v_mov_b32 v62, 0xff800000
    v_mov_b32 v63, 0xff800000
K2_fix2:
    s_cmp_lt_u32 s43, 5
    s_cbranch_scc0 K2_fix3
    v_mov_b32 v64, 0xff800000
    v_mov_b32 v65, 0xff800000
    v_mov_b32 v66, 0xff800000
    v_mov_b32 v67, 0xff800000
    v_mov_b32 v68, 0xff800000
    v_mov_b32 v69, 0xff800000
    v_mov_b32 v70, 0xff800000
    v_mov_b32 v71, 0xff800000
    v_mov_b32 v72, 0xff800000
    v_mov_b32 v73, 0xff800000
    v_mov_b32 v74, 0xff800000
    v_mov_b32 v75, 0xff800000
    v_mov_b32 v76, 0xff800000
    v_mov_b32 v77, 0xff800000
    v_mov_b32 v78, 0xff800000
    v_mov_b32 v79, 0xff800000
K2_fix3:
    s_cmp_lt_u32 s43, 4
    s_cbranch_scc0 K2_fix4
    v_mov_b32 v80, 0xff800000
    v_mov_b32 v81, 0xff800000
    v_mov_b32 v82, 0xff800000
    v_mov_b32 v83, 0xff800000
    v_mov_b32 v84, 0xff800000
    v_mov_b32 v85, 0xff800000
    v_mov_b32 v86, 0xff800000
    v_mov_b32 v87, 0xff800000
    v_mov_b32 v88, 0xff800000
    v_mov_b32 v89, 0xff800000
    v_mov_b32 v90, 0xff800000
    v_mov_b32 v91, 0xff800000
    v_mov_b32 v92, 0xff800000
    v_mov_b32 v93, 0xff800000
    v_mov_b32 v94, 0xff800000
    v_mov_b32 v95, 0xff800000
K2_fix4:
    s_cmp_lt_u32 s43, 3
    s_cbranch_scc0 K2_fix5
    v_mov_b32 v96, 0xff800000
    v_mov_b32 v97, 0xff800000
    v_mov_b32 v98, 0xff800000
    v_mov_b32 v99, 0xff800000
    v_mov_b32 v100, 0xff800000
    v_mov_b32 v101, 0xff800000
    v_mov_b32 v102, 0xff800000
    v_mov_b32 v103, 0xff800000
    v_mov_b32 v104, 0xff800000
    v_mov_b32 v105, 0xff800000
    v_mov_b32 v106, 0xff800000
    v_mov_b32 v107, 0xff800000
    v_mov_b32 v108, 0xff800000
    v_mov_b32 v109, 0xff800000
    v_mov_b32 v110, 0xff800000
    v_mov_b32 v111, 0xff800000
K2_fix5:
    s_cmp_lt_u32 s43, 2
    s_cbranch_scc0 K2_fix6
    v_mov_b32 v112, 0xff800000
    v_mov_b32 v113, 0xff800000
    v_mov_b32 v114, 0xff800000
    v_mov_b32 v115, 0xff800000
    v_mov_b32 v116, 0xff800000
    v_mov_b32 v117, 0xff800000
    v_mov_b32 v118, 0xff800000
    v_mov_b32 v119, 0xff800000
    v_mov_b32 v120, 0xff800000
    v_mov_b32 v121, 0xff800000
    v_mov_b32 v122, 0xff800000
    v_mov_b32 v123, 0xff800000
    v_mov_b32 v124, 0xff800000
    v_mov_b32 v125, 0xff800000
    v_mov_b32 v126, 0xff800000
    v_mov_b32 v127, 0xff800000
K2_fix6:
    s_cmp_lt_u32 s43, 1
    s_cbranch_scc0 K2_fix7
    v_mov_b32 v128, 0xff800000
    v_mov_b32 v129, 0xff800000
    v_mov_b32 v130, 0xff800000
    v_mov_b32 v131, 0xff800000
    v_mov_b32 v132, 0xff800000
    v_mov_b32 v133, 0xff800000
    v_mov_b32 v134, 0xff800000
    v_mov_b32 v135, 0xff800000
    v_mov_b32 v136, 0xff800000
    v_mov_b32 v137, 0xff800000
    v_mov_b32 v138, 0xff800000
    v_mov_b32 v139, 0xff800000
    v_mov_b32 v140, 0xff800000
    v_mov_b32 v141, 0xff800000
    v_mov_b32 v142, 0xff800000
    v_mov_b32 v143, 0xff800000
K2_fix7:
    v_max3_f32 v2, v16, v17, v18
    v_max3_f32 v3, v19, v20, v21
    v_max3_f32 v4, v22, v23, v24
    v_max3_f32 v5, v25, v26, v27
    v_max3_f32 v2, v2, v28, v29
    v_max3_f32 v3, v3, v30, v31
    v_max3_f32 v2, v2, v32, v33
    v_max3_f32 v3, v3, v34, v35
    v_max3_f32 v4, v4, v36, v37
    v_max3_f32 v5, v5, v38, v39
    v_max3_f32 v2, v2, v40, v41
    v_max3_f32 v3, v3, v42, v43
    v_max3_f32 v4, v4, v44, v45
    v_max3_f32 v5, v5, v46, v47
    v_max3_f32 v2, v2, v48, v49
    v_max3_f32 v3, v3, v50, v51
    v_max3_f32 v4, v4, v52, v53
    v_max3_f32 v5, v5, v54, v55
    v_max3_f32 v2, v2, v56, v57
    v_max3_f32 v3, v3, v58, v59
    v_max3_f32 v4, v4, v60, v61
    v_max3_f32 v5, v5, v62, v63
    v_max3_f32 v2, v2, v64, v65
    v_max3_f32 v3, v3, v66, v67
    v_max3_f32 v4, v4, v68, v69
    v_max3_f32 v5, v5, v70, v71
    v_max3_f32 v2, v2, v72, v73
    v_max3_f32 v3, v3, v74, v75
    v_max3_f32 v4, v4, v76, v77
    v_max3_f32 v5, v5, v78, v79
    v_max3_f32 v2, v2, v80, v81
    v_max3_f32 v3, v3, v82, v83
    v_max3_f32 v4, v4, v84, v85
    v_max3_f32 v5, v5, v86, v87
    v_max3_f32 v2, v2, v88, v89
    v_max3_f32 v3, v3, v90, v91
    v_max3_f32 v4, v4, v92, v93
    v_max3_f32 v5, v5, v94, v95
    v_max3_f32 v2, v2, v96, v97
    v_max3_f32 v3, v3, v98, v99
    v_max3_f32 v4, v4, v100, v101
    v_max3_f32 v5, v5, v102, v103
    v_max3_f32 v2, v2, v104, v105
    v_max3_f32 v3, v3, v106, v107
    v_max3_f32 v4, v4, v108, v109
    v_max3_f32 v5, v5, v110, v111
    v_max3_f32 v2, v2, v112, v113
    v_max3_f32 v3, v3, v114, v115
    v_max3_f32 v4, v4, v116, v117
    v_max3_f32 v5, v5, v118, v119
    v_max3_f32 v2, v2, v120, v121
    v_max3_f32 v3, v3, v122, v123
    v_max3_f32 v4, v4, v124, v125
    v_max3_f32 v5, v5, v126, v127
    v_max3_f32 v2, v2, v128, v129
    v_max3_f32 v3, v3, v130, v131
    v_max3_f32 v4, v4, v132, v133
    v_max3_f32 v5, v5, v134, v135
    v_max3_f32 v2, v2, v136, v137
    v_max3_f32 v3, v3, v138, v139
    v_max3_f32 v4, v4, v140, v141
    v_max3_f32 v5, v5, v142, v143
    v_max3_f32 v2, v2, v144, v145
    v_max3_f32 v3, v3, v146, v147
    v_max3_f32 v4, v4, v148, v149
    v_max3_f32 v5, v5, v150, v151
    v_max3_f32 v2, v2, v152, v153
    v_max3_f32 v3, v3, v154, v155
    v_max3_f32 v4, v4, v156, v157
    v_max3_f32 v5, v5, v158, v159
K2_qkdone:
    v_max3_f32 v2, v2, v3, v4
    v_max_f32 v2, v2, v5
    v_mov_b32 v3, v2
    s_nop 1
    v_permlane32_swap_b32 v2, v3
    v_max_f32 v2, v2, v3
    v_sub_f32 v250, 0, v2
    v_sub_f32 v251, 0, v2
    v_pk_add_f32 v[16:17], v[16:17], v[250:251]
    v_pk_add_f32 v[18:19], v[18:19], v[250:251]
    v_pk_add_f32 v[20:21], v[20:21], v[250:251]
    v_pk_add_f32 v[22:23], v[22:23], v[250:251]
    v_pk_add_f32 v[24:25], v[24:25], v[250:251]
    v_pk_add_f32 v[26:27], v[26:27], v[250:251]
    v_pk_add_f32 v[28:29], v[28:29], v[250:251]
    v_pk_add_f32 v[30:31], v[30:31], v[250:251]
    v_exp_f32 v16, v16
    v_exp_f32 v17, v17
    v_exp_f32 v18, v18
    v_exp_f32 v19, v19
    v_exp_f32 v20, v20
    ds_read_b64_tr_b16 v[228:229], v245
    v_exp_f32 v21, v21
    ds_read_b64_tr_b16 v[230:231], v245 offset:256
    v_exp_f32 v22, v22
    v_add_u32 v245, v246, v245
    v_exp_f32 v23, v23
    ds_read_b64_tr_b16 v[232:233], v245
    v_exp_f32 v24, v24
    ds_read_b64_tr_b16 v[234:235], v245 offset:256
    v_exp_f32 v25, v25
    v_add_u32 v245, v246, v245
    v_exp_f32 v26, v26
    v_exp_f32 v27, v27
    v_exp_f32 v28, v28
    v_exp_f32 v29, v29
    v_exp_f32 v30, v30
    v_exp_f32 v31, v31
    v_cvt_pk_bf16_f32 v16, v16, v17
    v_cvt_pk_bf16_f32 v17, v18, v19
    v_cvt_pk_bf16_f32 v18, v20, v21
    v_cvt_pk_bf16_f32 v19, v22, v23
    v_cvt_pk_bf16_f32 v20, v24, v25
    v_cvt_pk_bf16_f32 v21, v26, v27
    v_cvt_pk_bf16_f32 v22, v28, v29
    v_cvt_pk_bf16_f32 v23, v30, v31
    v_pk_add_f32 v[32:33], v[32:33], v[250:251]
    v_pk_add_f32 v[34:35], v[34:35], v[250:251]
    v_pk_add_f32 v[36:37], v[36:37], v[250:251]
    s_waitcnt lgkmcnt(4)
    v_mfma_f32_32x32x16_bf16 v[160:175], v[220:223], v[16:19], 0
    v_pk_add_f32 v[38:39], v[38:39], v[250:251]
    v_pk_add_f32 v[40:41], v[40:41], v[250:251]
    v_pk_add_f32 v[42:43], v[42:43], v[250:251]
    v_pk_add_f32 v[44:45], v[44:45], v[250:251]
    v_pk_add_f32 v[46:47], v[46:47], v[250:251]
    v_exp_f32 v32, v32
    v_exp_f32 v33, v33
    v_exp_f32 v34, v34
    v_exp_f32 v35, v35
    v_mfma_f32_32x32x16_bf16 v[160:175], v[224:227], v[20:23], v[160:175]
    v_exp_f32 v36, v36
    ds_read_b64_tr_b16 v[220:221], v245
    v_exp_f32 v37, v37
    ds_read_b64_tr_b16 v[222:223], v245 offset:256
    v_exp_f32 v38, v38
    v_add_u32 v245, v246, v245
    v_exp_f32 v39, v39
    ds_read_b64_tr_b16 v[224:225], v245
    v_exp_f32 v40, v40
    ds_read_b64_tr_b16 v[226:227], v245 offset:256
    v_exp_f32 v41, v41
    v_add_u32 v245, v246, v245
    v_exp_f32 v42, v42
    v_exp_f32 v43, v43
    v_exp_f32 v44, v44
    v_exp_f32 v45, v45
    v_exp_f32 v46, v46
    v_exp_f32 v47, v47
    v_cvt_pk_bf16_f32 v32, v32, v33
    v_cvt_pk_bf16_f32 v33, v34, v35
    v_cvt_pk_bf16_f32 v34, v36, v37
    v_cvt_pk_bf16_f32 v35, v38, v39
    v_cvt_pk_bf16_f32 v36, v40, v41
    v_cvt_pk_bf16_f32 v37, v42, v43
    v_cvt_pk_bf16_f32 v38, v44, v45
    v_cvt_pk_bf16_f32 v39, v46, v47
    v_pk_add_f32 v[48:49], v[48:49], v[250:251]
    v_pk_add_f32 v[50:51], v[50:51], v[250:251]
    v_pk_add_f32 v[52:53], v[52:53], v[250:251]
    s_waitcnt lgkmcnt(4)
    v_mfma_f32_32x32x16_bf16 v[160:175], v[228:231], v[32:35], v[160:175]
    v_pk_add_f32 v[54:55], v[54:55], v[250:251]
    v_pk_add_f32 v[56:57], v[56:57], v[250:251]
    v_pk_add_f32 v[58:59], v[58:59], v[250:251]
    v_pk_add_f32 v[60:61], v[60:61], v[250:251]
    v_pk_add_f32 v[62:63], v[62:63], v[250:251]
    v_exp_f32 v48, v48
    v_exp_f32 v49, v49
    v_exp_f32 v50, v50
    v_exp_f32 v51, v51
    v_mfma_f32_32x32x16_bf16 v[160:175], v[232:235], v[36:39], v[160:175]
    v_exp_f32 v52, v52
    ds_read_b64_tr_b16 v[228:229], v245
    v_exp_f32 v53, v53
    ds_read_b64_tr_b16 v[230:231], v245 offset:256
    v_exp_f32 v54, v54
    v_add_u32 v245, v246, v245
    v_exp_f32 v55, v55
    ds_read_b64_tr_b16 v[232:233], v245
    v_exp_f32 v56, v56
    ds_read_b64_tr_b16 v[234:235], v245 offset:256
    v_exp_f32 v57, v57
    v_add_u32 v245, v246, v245
    v_exp_f32 v58, v58
    v_exp_f32 v59, v59
    v_exp_f32 v60, v60
    v_exp_f32 v61, v61
    v_exp_f32 v62, v62
    v_exp_f32 v63, v63
    v_cvt_pk_bf16_f32 v48, v48, v49
    v_cvt_pk_bf16_f32 v49, v50, v51
    v_cvt_pk_bf16_f32 v50, v52, v53
    v_cvt_pk_bf16_f32 v51, v54, v55
    v_cvt_pk_bf16_f32 v52, v56, v57
    v_cvt_pk_bf16_f32 v53, v58, v59
    v_cvt_pk_bf16_f32 v54, v60, v61
    v_cvt_pk_bf16_f32 v55, v62, v63
    v_pk_add_f32 v[64:65], v[64:65], v[250:251]
    v_pk_add_f32 v[66:67], v[66:67], v[250:251]
    v_pk_add_f32 v[68:69], v[68:69], v[250:251]
    s_waitcnt lgkmcnt(4)
    v_mfma_f32_32x32x16_bf16 v[160:175], v[220:223], v[48:51], v[160:175]
    v_pk_add_f32 v[70:71], v[70:71], v[250:251]
    v_pk_add_f32 v[72:73], v[72:73], v[250:251]
    v_pk_add_f32 v[74:75], v[74:75], v[250:251]
    v_pk_add_f32 v[76:77], v[76:77], v[250:251]
    v_pk_add_f32 v[78:79], v[78:79], v[250:251]
    v_exp_f32 v64, v64
    v_exp_f32 v65, v65
    v_exp_f32 v66, v66
    v_exp_f32 v67, v67
    v_mfma_f32_32x32x16_bf16 v[160:175], v[224:227], v[52:55], v[160:175]
    v_exp_f32 v68, v68
    ds_read_b64_tr_b16 v[220:221], v245
    v_exp_f32 v69, v69
    ds_read_b64_tr_b16 v[222:223], v245 offset:256
    v_exp_f32 v70, v70
    v_add_u32 v245, v246, v245
    v_exp_f32 v71, v71
    ds_read_b64_tr_b16 v[224:225], v245
    v_exp_f32 v72, v72
    ds_read_b64_tr_b16 v[226:227], v245 offset:256
    v_exp_f32 v73, v73
    v_add_u32 v245, v246, v245
    v_exp_f32 v74, v74
    v_exp_f32 v75, v75
    v_exp_f32 v76, v76
    v_exp_f32 v77, v77
    v_exp_f32 v78, v78
    v_exp_f32 v79, v79
    v_cvt_pk_bf16_f32 v64, v64, v65
    v_cvt_pk_bf16_f32 v65, v66, v67
    v_cvt_pk_bf16_f32 v66, v68, v69
    v_cvt_pk_bf16_f32 v67, v70, v71
    v_cvt_pk_bf16_f32 v68, v72, v73
    v_cvt_pk_bf16_f32 v69, v74, v75
    v_cvt_pk_bf16_f32 v70, v76, v77
    v_cvt_pk_bf16_f32 v71, v78, v79
    v_pk_add_f32 v[80:81], v[80:81], v[250:251]
    v_pk_add_f32 v[82:83], v[82:83], v[250:251]
    v_pk_add_f32 v[84:85], v[84:85], v[250:251]
    s_waitcnt lgkmcnt(4)
    v_mfma_f32_32x32x16_bf16 v[160:175], v[228:231], v[64:67], v[160:175]
    v_pk_add_f32 v[86:87], v[86:87], v[250:251]
    v_pk_add_f32 v[88:89], v[88:89], v[250:251]
    v_pk_add_f32 v[90:91], v[90:91], v[250:251]
    v_pk_add_f32 v[92:93], v[92:93], v[250:251]
    v_pk_add_f32 v[94:95], v[94:95], v[250:251]
    v_exp_f32 v80, v80
    v_exp_f32 v81, v81
    v_exp_f32 v82, v82
    v_exp_f32 v83, v83
    v_mfma_f32_32x32x16_bf16 v[160:175], v[232:235], v[68:71], v[160:175]
    v_exp_f32 v84, v84
    ds_read_b64_tr_b16 v[228:229], v245
    v_exp_f32 v85, v85
    ds_read_b64_tr_b16 v[230:231], v245 offset:256
    v_exp_f32 v86, v86
    v_add_u32 v245, v246, v245
    v_exp_f32 v87, v87
    ds_read_b64_tr_b16 v[232:233], v245
    v_exp_f32 v88, v88
    ds_read_b64_tr_b16 v[234:235], v245 offset:256
    v_exp_f32 v89, v89
    v_add_u32 v245, v246, v245
    v_exp_f32 v90, v90
    v_exp_f32 v91, v91
    v_exp_f32 v92, v92
    v_exp_f32 v93, v93
    v_exp_f32 v94, v94
    v_exp_f32 v95, v95
    v_cvt_pk_bf16_f32 v80, v80, v81
    v_cvt_pk_bf16_f32 v81, v82, v83
    v_cvt_pk_bf16_f32 v82, v84, v85
    v_cvt_pk_bf16_f32 v83, v86, v87
    v_cvt_pk_bf16_f32 v84, v88, v89
    v_cvt_pk_bf16_f32 v85, v90, v91
    v_cvt_pk_bf16_f32 v86, v92, v93
    v_cvt_pk_bf16_f32 v87, v94, v95
    v_pk_add_f32 v[96:97], v[96:97], v[250:251]
    v_pk_add_f32 v[98:99], v[98:99], v[250:251]
    v_pk_add_f32 v[100:101], v[100:101], v[250:251]
    s_waitcnt lgkmcnt(4)
    v_mfma_f32_32x32x16_bf16 v[160:175], v[220:223], v[80:83], v[160:175]
    v_pk_add_f32 v[102:103], v[102:103], v[250:251]
    v_pk_add_f32 v[104:105], v[104:105], v[250:251]
    v_pk_add_f32 v[106:107], v[106:107], v[250:251]
    v_pk_add_f32 v[108:109], v[108:109], v[250:251]
    v_pk_add_f32 v[110:111], v[110:111], v[250:251]
    v_exp_f32 v96, v96
    v_exp_f32 v97, v97
    v_exp_f32 v98, v98
    v_exp_f32 v99, v99
    v_mfma_f32_32x32x16_bf16 v[160:175], v[224:227], v[84:87], v[160:175]
    v_exp_f32 v100, v100
    ds_read_b64_tr_b16 v[220:221], v245
    v_exp_f32 v101, v101
    ds_read_b64_tr_b16 v[222:223], v245 offset:256
    v_exp_f32 v102, v102
    v_add_u32 v245, v246, v245
    v_exp_f32 v103, v103
    ds_read_b64_tr_b16 v[224:225], v245
    v_exp_f32 v104, v104
    ds_read_b64_tr_b16 v[226:227], v245 offset:256
    v_exp_f32 v105, v105
    v_add_u32 v245, v246, v245
    v_exp_f32 v106, v106
    v_exp_f32 v107, v107
    v_exp_f32 v108, v108
    v_exp_f32 v109, v109
    v_exp_f32 v110, v110
    v_exp_f32 v111, v111
    v_cvt_pk_bf16_f32 v96, v96, v97
    v_cvt_pk_bf16_f32 v97, v98, v99
    v_cvt_pk_bf16_f32 v98, v100, v101
    v_cvt_pk_bf16_f32 v99, v102, v103
    v_cvt_pk_bf16_f32 v100, v104, v105
    v_cvt_pk_bf16_f32 v101, v106, v107
    v_cvt_pk_bf16_f32 v102, v108, v109
    v_cvt_pk_bf16_f32 v103, v110, v111
    v_pk_add_f32 v[112:113], v[112:113], v[250:251]
    v_pk_add_f32 v[114:115], v[114:115], v[250:251]
    v_pk_add_f32 v[116:117], v[116:117], v[250:251]
    s_waitcnt lgkmcnt(4)
    v_mfma_f32_32x32x16_bf16 v[160:175], v[228:231], v[96:99], v[160:175]
    v_pk_add_f32 v[118:119], v[118:119], v[250:251]
    v_pk_add_f32 v[120:121], v[120:121], v[250:251]
    v_pk_add_f32 v[122:123], v[122:123], v[250:251]
    v_pk_add_f32 v[124:125], v[124:125], v[250:251]
    v_pk_add_f32 v[126:127], v[126:127], v[250:251]
    v_exp_f32 v112, v112
    v_exp_f32 v113, v113
    v_exp_f32 v114, v114
    v_exp_f32 v115, v115
    v_mfma_f32_32x32x16_bf16 v[160:175], v[232:235], v[100:103], v[160:175]
    v_exp_f32 v116, v116
    ds_read_b64_tr_b16 v[228:229], v245
    v_exp_f32 v117, v117
    ds_read_b64_tr_b16 v[230:231], v245 offset:256
    v_exp_f32 v118, v118
    v_add_u32 v245, v246, v245
    v_exp_f32 v119, v119
    ds_read_b64_tr_b16 v[232:233], v245
    v_exp_f32 v120, v120
    ds_read_b64_tr_b16 v[234:235], v245 offset:256
    v_exp_f32 v121, v121
    v_add_u32 v245, v246, v245
    v_exp_f32 v122, v122
    v_exp_f32 v123, v123
    v_exp_f32 v124, v124
    v_exp_f32 v125, v125
    v_exp_f32 v126, v126
    v_exp_f32 v127, v127
    v_cvt_pk_bf16_f32 v112, v112, v113
    v_cvt_pk_bf16_f32 v113, v114, v115
    v_cvt_pk_bf16_f32 v114, v116, v117
    v_cvt_pk_bf16_f32 v115, v118, v119
    v_cvt_pk_bf16_f32 v116, v120, v121
    v_cvt_pk_bf16_f32 v117, v122, v123
    v_cvt_pk_bf16_f32 v118, v124, v125
    v_cvt_pk_bf16_f32 v119, v126, v127
    v_pk_add_f32 v[128:129], v[128:129], v[250:251]
    v_pk_add_f32 v[130:131], v[130:131], v[250:251]
    v_pk_add_f32 v[132:133], v[132:133], v[250:251]
    s_waitcnt lgkmcnt(4)
    v_mfma_f32_32x32x16_bf16 v[160:175], v[220:223], v[112:115], v[160:175]
    v_pk_add_f32 v[134:135], v[134:135], v[250:251]
    v_pk_add_f32 v[136:137], v[136:137], v[250:251]
    v_pk_add_f32 v[138:139], v[138:139], v[250:251]
    v_pk_add_f32 v[140:141], v[140:141], v[250:251]
    v_pk_add_f32 v[142:143], v[142:143], v[250:251]
    v_exp_f32 v128, v128
    v_exp_f32 v129, v129
    v_exp_f32 v130, v130
    v_exp_f32 v131, v131
    v_mfma_f32_32x32x16_bf16 v[160:175], v[224:227], v[116:119], v[160:175]
    v_exp_f32 v132, v132
    ds_read_b64_tr_b16 v[220:221], v245
    v_exp_f32 v133, v133
    ds_read_b64_tr_b16 v[222:223], v245 offset:256
    v_exp_f32 v134, v134
    v_add_u32 v245, v246, v245
    v_exp_f32 v135, v135
    ds_read_b64_tr_b16 v[224:225], v245
    v_exp_f32 v136, v136
    ds_read_b64_tr_b16 v[226:227], v245 offset:256
    v_exp_f32 v137, v137
    v_add_u32 v245, v246, v245
    v_exp_f32 v138, v138
    v_exp_f32 v139, v139
    v_exp_f32 v140, v140
    v_exp_f32 v141, v141
    v_exp_f32 v142, v142
    v_exp_f32 v143, v143
    v_cvt_pk_bf16_f32 v128, v128, v129
    v_cvt_pk_bf16_f32 v129, v130, v131
    v_cvt_pk_bf16_f32 v130, v132, v133
    v_cvt_pk_bf16_f32 v131, v134, v135
    v_cvt_pk_bf16_f32 v132, v136, v137
    v_cvt_pk_bf16_f32 v133, v138, v139
    v_cvt_pk_bf16_f32 v134, v140, v141
    v_cvt_pk_bf16_f32 v135, v142, v143
    v_pk_add_f32 v[144:145], v[144:145], v[250:251]
    v_pk_add_f32 v[146:147], v[146:147], v[250:251]
    v_pk_add_f32 v[148:149], v[148:149], v[250:251]
    s_waitcnt lgkmcnt(4)
    v_mfma_f32_32x32x16_bf16 v[160:175], v[228:231], v[128:131], v[160:175]
    v_pk_add_f32 v[150:151], v[150:151], v[250:251]
    v_pk_add_f32 v[152:153], v[152:153], v[250:251]
    v_pk_add_f32 v[154:155], v[154:155], v[250:251]
    v_pk_add_f32 v[156:157], v[156:157], v[250:251]
    v_pk_add_f32 v[158:159], v[158:159], v[250:251]
    v_exp_f32 v144, v144
    v_exp_f32 v145, v145
    v_exp_f32 v146, v146
    v_exp_f32 v147, v147
    v_mfma_f32_32x32x16_bf16 v[160:175], v[232:235], v[132:135], v[160:175]
    v_exp_f32 v148, v148
    v_exp_f32 v149, v149
    v_exp_f32 v150, v150
    v_exp_f32 v151, v151
    v_exp_f32 v152, v152
    v_exp_f32 v153, v153
    v_exp_f32 v154, v154
    v_exp_f32 v155, v155
    v_exp_f32 v156, v156
    v_exp_f32 v157, v157
    v_exp_f32 v158, v158
    v_exp_f32 v159, v159
    v_cvt_pk_bf16_f32 v144, v144, v145
    v_cvt_pk_bf16_f32 v145, v146, v147
    v_cvt_pk_bf16_f32 v146, v148, v149
    v_cvt_pk_bf16_f32 v147, v150, v151
    v_cvt_pk_bf16_f32 v148, v152, v153
    v_cvt_pk_bf16_f32 v149, v154, v155
    v_cvt_pk_bf16_f32 v150, v156, v157
    v_cvt_pk_bf16_f32 v151, v158, v159
    s_waitcnt lgkmcnt(0)
    v_mfma_f32_32x32x16_bf16 v[160:175], v[220:223], v[144:147], v[160:175]
    v_mfma_f32_32x32x16_bf16 v[160:175], v[224:227], v[148:151], v[160:175]
K2_afin:
    s_nop 11
    v_rcp_f32 v2, v168
    s_nop 0
    v_mul_f32 v2, v2, v11
    v_mul_f32 v160, v160, v2
    v_mul_f32 v161, v161, v2
    v_mul_f32 v162, v162, v2
    v_mul_f32 v163, v163, v2
    v_mul_f32 v164, v164, v2
    v_mul_f32 v165, v165, v2
    v_mul_f32 v166, v166, v2
    v_mul_f32 v167, v167, v2
    v_cvt_pk_bf16_f32 v4, v160, v161
    v_cvt_pk_bf16_f32 v5, v162, v163
    v_cvt_pk_bf16_f32 v6, v164, v165
    v_cvt_pk_bf16_f32 v7, v166, v167
    s_mov_b32 s43, 14680064
    buffer_store_dwordx2 v[4:5], v10, s[32:35], s43 offen sc1
    buffer_store_dwordx2 v[6:7], v10, s[32:35], s43 offen offset:256 sc1
    v_add_u32 v10, 90112, v10
    v_add_u32 v244, 1024, v244
    v_mov_b32 v6, 4294959104
    v_and_b32 v7, 16, v1
    v_cmp_eq_u32 s[52:53], 0, v7
    s_nop 1
    v_cndmask_b32 v6, 0, v6, s[52:53]
    v_add_u32 v245, v6, v245
    s_add_u32 s40, s40, 1
    s_cmp_lt_u32 s40, 2
    s_cbranch_scc1 K2_aloop
    s_waitcnt vmcnt(0)
    s_barrier
    s_cmp_eq_u32 s20, 0
    s_cbranch_scc0 K2_fa
    s_lshl_b32 s43, s16, 5
    s_add_u32 s43, s43, s17
    s_lshl_b32 s43, s43, 2
    s_add_u32 s43, s43, 21561344
    v_mov_b32 v4, 0
    v_mov_b32 v5, 1
    s_mov_b64 s[52:53], exec
    s_mov_b64 exec, 1
    buffer_store_dword v5, v4, s[32:35], s43 offen sc1
    s_mov_b64 exec, s[52:53]
K2_fa:
    s_setprio 0
    s_lshl_b32 s18, s14, 2
    s_and_b32 s43, s15, 3
    s_add_u32 s18, s18, s43
    s_lshr_b32 s19, s15, 2
    s_mov_b32 s24, s56
    s_mov_b32 s25, s57
    s_mov_b32 s26, 524288
    s_mov_b32 s27, 0x20000
    s_mov_b32 s28, s58
    s_mov_b32 s29, s59
    s_mov_b32 s30, 917504
    s_mov_b32 s31, 0x20000
    s_mov_b32 s36, s60
    s_mov_b32 s37, s61
    s_mov_b32 s38, 2097152
    s_mov_b32 s39, 0x20000
    v_lshrrev_b32 v2, 3, v1
    v_and_b32 v3, 7, v1
    v_and_b32 v4, 3, v2
    v_lshrrev_b32 v5, 2, v2
    v_lshl_add_u32 v4, v5, 3, v4
    s_lshl_b32 s43, s20, 4
    v_add_u32 v4, s43, v4
    v_lshlrev_b32 v4, 10, v4
    v_lshrrev_b32 v5, 1, v2
    v_lshlrev_b32 v5, 1, v5
    v_xor_b32 v5, v3, v5
    v_lshl_add_u32 v4, v5, 4, v4
    s_lshl_b32 s43, s19, 7
    v_add_u32 v12, s43, v4
    v_add_u32 v13, 3072, v12
    s_lshl_b32 s47, s20, 11
    s_lshl_b32 s48, s18, 2
    s_add_u32 s48, s48, s20
    v_lshlrev_b32 v14, 4, v1
    s_mul_i32 s48, s48, 45056
    s_add_u32 s48, s48, 14680064
    s_add_u32 m0, s47, 0
    s_mov_b32 s44, 0
    buffer_load_dwordx4 v12, s[24:27], s44 offen offset:0 lds
    buffer_load_dwordx4 v13, s[24:27], s44 offen offset:1024 lds
    s_add_u32 m0, s47, 8192
    s_mov_b32 s44, 65536
    buffer_load_dwordx4 v12, s[24:27], s44 offen offset:0 lds
    buffer_load_dwordx4 v13, s[24:27], s44 offen offset:1024 lds
    s_add_u32 m0, s47, 16384
    s_mov_b32 s44, 131072
    buffer_load_dwordx4 v12, s[24:27], s44 offen offset:0 lds
    buffer_load_dwordx4 v13, s[24:27], s44 offen offset:1024 lds
    s_add_u32 m0, s47, 24576
    s_mov_b32 s44, 196608
    buffer_load_dwordx4 v12, s[24:27], s44 offen offset:0 lds
    buffer_load_dwordx4 v13, s[24:27], s44 offen offset:1024 lds
    s_add_u32 m0, s47, 32768
    s_mov_b32 s44, 262144
    buffer_load_dwordx4 v12, s[24:27], s44 offen offset:0 lds
    buffer_load_dwordx4 v13, s[24:27], s44 offen offset:1024 lds
    s_add_u32 m0, s47, 40960
    s_mov_b32 s44, 327680
    buffer_load_dwordx4 v12, s[24:27], s44 offen offset:0 lds
    buffer_load_dwordx4 v13, s[24:27], s44 offen offset:1024 lds
    v_lshrrev_b32 v4, 2, v1
    v_and_b32 v4, 7, v4
    v_lshrrev_b32 v5, 5, v1
    v_lshlrev_b32 v5, 11, v5
    v_lshl_add_u32 v5, v4, 7, v5
    v_lshrrev_b32 v4, 1, v4
    v_lshl_add_u32 v5, v4, 5, v5
    v_and_b32 v4, 3, v1
    v_lshl_add_u32 v5, v4, 3, v5
    v_xor_b32 v8, 0, v5
    v_xor_b32 v9, 32, v5
    v_xor_b32 v10, 64, v5
    v_xor_b32 v11, 96, v5
    v_mov_b32 v16, 0
    v_mov_b32 v17, 0
    v_mov_b32 v18, 0
    v_mov_b32 v19, 0
    v_mov_b32 v20, 0
    v_mov_b32 v21, 0
    v_mov_b32 v22, 0
    v_mov_b32 v23, 0
    v_mov_b32 v24, 0
    v_mov_b32 v25, 0
    v_mov_b32 v26, 0
    v_mov_b32 v27, 0
    v_mov_b32 v28, 0
    v_mov_b32 v29, 0
    v_mov_b32 v30, 0
    v_mov_b32 v31, 0
    s_cmp_eq_u32 s20, 0
    s_cbranch_scc0 K2_npa
    s_lshl_b32 s43, s14, 7
    s_add_u32 s43, s43, 21561344
    v_and_b32 v2, 31, v1
    v_lshlrev_b32 v2, 2, v2
    s_mov_b32 s49, 0
K2_pla:
    buffer_load_dword v3, v2, s[32:35], s43 offen sc1
    s_waitcnt vmcnt(0)
    v_cmp_eq_u32 vcc, 0, v3
    s_add_u32 s49, s49, 1
    s_cmp_ge_u32 s49, 0x40000
    s_cbranch_scc1 K2_npa
    s_cbranch_vccnz K2_pla
K2_npa:
    s_barrier
    s_add_u32 s43, s48, 0
    buffer_load_dwordx4 v[96:99], v14, s[32:35], s43 offen offset:0 sc1
    buffer_load_dwordx4 v[100:103], v14, s[32:35], s43 offen offset:1024 sc1
    s_add_u32 s43, s48, 2048
    buffer_load_dwordx4 v[104:107], v14, s[32:35], s43 offen offset:0 sc1
    buffer_load_dwordx4 v[108:111], v14, s[32:35], s43 offen offset:1024 sc1
    s_add_u32 s43, s48, 4096
    buffer_load_dwordx4 v[112:115], v14, s[32:35], s43 offen offset:0 sc1
    buffer_load_dwordx4 v[116:119], v14, s[32:35], s43 offen offset:1024 sc1
    s_add_u32 s43, s48, 6144
    buffer_load_dwordx4 v[120:123], v14, s[32:35], s43 offen offset:0 sc1
    buffer_load_dwordx4 v[124:127], v14, s[32:35], s43 offen offset:1024 sc1
    s_add_u32 s43, s48, 8192
    buffer_load_dwordx4 v[128:131], v14, s[32:35], s43 offen offset:0 sc1
    buffer_load_dwordx4 v[132:135], v14, s[32:35], s43 offen offset:1024 sc1
    s_waitcnt vmcnt(20)
    s_barrier
    ds_read_b64_tr_b16 v[32:33], v8 offset:0
    ds_read_b64_tr_b16 v[34:35], v8 offset:1024
    ds_read_b64_tr_b16 v[36:37], v9 offset:0
    ds_read_b64_tr_b16 v[38:39], v9 offset:1024
    ds_read_b64_tr_b16 v[40:41], v10 offset:0
    ds_read_b64_tr_b16 v[42:43], v10 offset:1024
    ds_read_b64_tr_b16 v[44:45], v11 offset:0
    ds_read_b64_tr_b16 v[46:47], v11 offset:1024
    ds_read_b64_tr_b16 v[48:49], v8 offset:4096
    ds_read_b64_tr_b16 v[50:51], v8 offset:5120
    ds_read_b64_tr_b16 v[52:53], v9 offset:4096
    ds_read_b64_tr_b16 v[54:55], v9 offset:5120
    ds_read_b64_tr_b16 v[56:57], v10 offset:4096
    ds_read_b64_tr_b16 v[58:59], v10 offset:5120
    ds_read_b64_tr_b16 v[60:61], v11 offset:4096
    ds_read_b64_tr_b16 v[62:63], v11 offset:5120
    s_waitcnt vmcnt(8) lgkmcnt(0)
    s_barrier
    s_add_u32 m0, s47, 0
    s_mov_b32 s44, 393216
    buffer_load_dwordx4 v12, s[24:27], s44 offen offset:0 lds
    v_mfma_f32_16x16x32_bf16 v[16:19], v[32:35], v[96:99], v[16:19]
    ds_read_b64_tr_b16 v[64:65], v8 offset:8192
    ds_read_b64_tr_b16 v[66:67], v8 offset:9216
    buffer_load_dwordx4 v13, s[24:27], s44 offen offset:1024 lds
    v_mfma_f32_16x16x32_bf16 v[20:23], v[36:39], v[96:99], v[20:23]
    ds_read_b64_tr_b16 v[68:69], v9 offset:8192
    ds_read_b64_tr_b16 v[70:71], v9 offset:9216
    s_add_u32 s43, s48, 10240
    buffer_load_dwordx4 v[136:139], v14, s[32:35], s43 offen offset:0 sc1
    v_mfma_f32_16x16x32_bf16 v[24:27], v[40:43], v[96:99], v[24:27]
    ds_read_b64_tr_b16 v[72:73], v10 offset:8192
    ds_read_b64_tr_b16 v[74:75], v10 offset:9216
    buffer_load_dwordx4 v[140:143], v14, s[32:35], s43 offen offset:1024 sc1
    v_mfma_f32_16x16x32_bf16 v[28:31], v[44:47], v[96:99], v[28:31]
    ds_read_b64_tr_b16 v[76:77], v11 offset:8192
    ds_read_b64_tr_b16 v[78:79], v11 offset:9216
    v_mfma_f32_16x16x32_bf16 v[16:19], v[48:51], v[100:103], v[16:19]
    ds_read_b64_tr_b16 v[80:81], v8 offset:12288
    ds_read_b64_tr_b16 v[82:83], v8 offset:13312
    v_mfma_f32_16x16x32_bf16 v[20:23], v[52:55], v[100:103], v[20:23]
    ds_read_b64_tr_b16 v[84:85], v9 offset:12288
    ds_read_b64_tr_b16 v[86:87], v9 offset:13312
    v_mfma_f32_16x16x32_bf16 v[24:27], v[56:59], v[100:103], v[24:27]
    ds_read_b64_tr_b16 v[88:89], v10 offset:12288
    ds_read_b64_tr_b16 v[90:91], v10 offset:13312
    v_mfma_f32_16x16x32_bf16 v[28:31], v[60:63], v[100:103], v[28:31]
    ds_read_b64_tr_b16 v[92:93], v11 offset:12288
    ds_read_b64_tr_b16 v[94:95], v11 offset:13312
    s_waitcnt vmcnt(10) lgkmcnt(0)
    s_barrier
    s_add_u32 m0, s47, 8192
    s_mov_b32 s44, 458752
    buffer_load_dwordx4 v12, s[24:27], s44 offen offset:0 lds
    v_mfma_f32_16x16x32_bf16 v[16:19], v[64:67], v[104:107], v[16:19]
    ds_read_b64_tr_b16 v[32:33], v8 offset:16384
    ds_read_b64_tr_b16 v[34:35], v8 offset:17408
    buffer_load_dwordx4 v13, s[24:27], s44 offen offset:1024 lds
    v_mfma_f32_16x16x32_bf16 v[20:23], v[68:71], v[104:107], v[20:23]
    ds_read_b64_tr_b16 v[36:37], v9 offset:16384
    ds_read_b64_tr_b16 v[38:39], v9 offset:17408
    s_add_u32 s43, s48, 12288
    buffer_load_dwordx4 v[96:99], v14, s[32:35], s43 offen offset:0 sc1
    v_mfma_f32_16x16x32_bf16 v[24:27], v[72:75], v[104:107], v[24:27]
    ds_read_b64_tr_b16 v[40:41], v10 offset:16384
    ds_read_b64_tr_b16 v[42:43], v10 offset:17408
    buffer_load_dwordx4 v[100:103], v14, s[32:35], s43 offen offset:1024 sc1
    v_mfma_f32_16x16x32_bf16 v[28:31], v[76:79], v[104:107], v[28:31]
    ds_read_b64_tr_b16 v[44:45], v11 offset:16384
    ds_read_b64_tr_b16 v[46:47], v11 offset:17408
    v_mfma_f32_16x16x32_bf16 v[16:19], v[80:83], v[108:111], v[16:19]
    ds_read_b64_tr_b16 v[48:49], v8 offset:20480
    ds_read_b64_tr_b16 v[50:51], v8 offset:21504
    v_mfma_f32_16x16x32_bf16 v[20:23], v[84:87], v[108:111], v[20:23]
    ds_read_b64_tr_b16 v[52:53], v9 offset:20480
    ds_read_b64_tr_b16 v[54:55], v9 offset:21504
    v_mfma_f32_16x16x32_bf16 v[24:27], v[88:91], v[108:111], v[24:27]
    ds_read_b64_tr_b16 v[56:57], v10 offset:20480
    ds_read_b64_tr_b16 v[58:59], v10 offset:21504
    v_mfma_f32_16x16x32_bf16 v[28:31], v[92:95], v[108:111], v[28:31]
    ds_read_b64_tr_b16 v[60:61], v11 offset:20480
    ds_read_b64_tr_b16 v[62:63], v11 offset:21504
    s_waitcnt vmcnt(12) lgkmcnt(0)
    s_barrier
    s_add_u32 m0, s47, 16384
    s_mov_b32 s44, 0
    buffer_load_dwordx4 v12, s[28:31], s44 offen offset:0 lds
    v_mfma_f32_16x16x32_bf16 v[16:19], v[32:35], v[112:115], v[16:19]
    ds_read_b64_tr_b16 v[64:65], v8 offset:24576
    ds_read_b64_tr_b16 v[66:67], v8 offset:25600
    buffer_load_dwordx4 v13, s[28:31], s44 offen offset:1024 lds
    v_mfma_f32_16x16x32_bf16 v[20:23], v[36:39], v[112:115], v[20:23]
    ds_read_b64_tr_b16 v[68:69], v9 offset:24576
    ds_read_b64_tr_b16 v[70:71], v9 offset:25600
    s_add_u32 s43, s48, 14336
    buffer_load_dwordx4 v[104:107], v14, s[32:35], s43 offen offset:0 sc1
    v_mfma_f32_16x16x32_bf16 v[24:27], v[40:43], v[112:115], v[24:27]
    ds_read_b64_tr_b16 v[72:73], v10 offset:24576
    ds_read_b64_tr_b16 v[74:75], v10 offset:25600
    buffer_load_dwordx4 v[108:111], v14, s[32:35], s43 offen offset:1024 sc1
    v_mfma_f32_16x16x32_bf16 v[28:31], v[44:47], v[112:115], v[28:31]
    ds_read_b64_tr_b16 v[76:77], v11 offset:24576
    ds_read_b64_tr_b16 v[78:79], v11 offset:25600
    v_mfma_f32_16x16x32_bf16 v[16:19], v[48:51], v[116:119], v[16:19]
    ds_read_b64_tr_b16 v[80:81], v8 offset:28672
    ds_read_b64_tr_b16 v[82:83], v8 offset:29696
    v_mfma_f32_16x16x32_bf16 v[20:23], v[52:55], v[116:119], v[20:23]
    ds_read_b64_tr_b16 v[84:85], v9 offset:28672
    ds_read_b64_tr_b16 v[86:87], v9 offset:29696
    v_mfma_f32_16x16x32_bf16 v[24:27], v[56:59], v[116:119], v[24:27]
    ds_read_b64_tr_b16 v[88:89], v10 offset:28672
    ds_read_b64_tr_b16 v[90:91], v10 offset:29696
    v_mfma_f32_16x16x32_bf16 v[28:31], v[60:63], v[116:119], v[28:31]
    ds_read_b64_tr_b16 v[92:93], v11 offset:28672
    ds_read_b64_tr_b16 v[94:95], v11 offset:29696
    s_waitcnt vmcnt(14) lgkmcnt(0)
    s_barrier
    s_add_u32 m0, s47, 24576
    s_mov_b32 s44, 65536
    buffer_load_dwordx4 v12, s[28:31], s44 offen offset:0 lds
    v_mfma_f32_16x16x32_bf16 v[16:19], v[64:67], v[120:123], v[16:19]
    ds_read_b64_tr_b16 v[32:33], v8 offset:32768
    ds_read_b64_tr_b16 v[34:35], v8 offset:33792
    buffer_load_dwordx4 v13, s[28:31], s44 offen offset:1024 lds
    v_mfma_f32_16x16x32_bf16 v[20:23], v[68:71], v[120:123], v[20:23]
    ds_read_b64_tr_b16 v[36:37], v9 offset:32768
    ds_read_b64_tr_b16 v[38:39], v9 offset:33792
    v_mfma_f32_16x16x32_bf16 v[24:27], v[72:75], v[120:123], v[24:27]
    ds_read_b64_tr_b16 v[40:41], v10 offset:32768
    ds_read_b64_tr_b16 v[42:43], v10 offset:33792
    v_mfma_f32_16x16x32_bf16 v[28:31], v[76:79], v[120:123], v[28:31]
    ds_read_b64_tr_b16 v[44:45], v11 offset:32768
    ds_read_b64_tr_b16 v[46:47], v11 offset:33792
    v_mfma_f32_16x16x32_bf16 v[16:19], v[80:83], v[124:127], v[16:19]
    ds_read_b64_tr_b16 v[48:49], v8 offset:36864
    ds_read_b64_tr_b16 v[50:51], v8 offset:37888
    v_mfma_f32_16x16x32_bf16 v[20:23], v[84:87], v[124:127], v[20:23]
    ds_read_b64_tr_b16 v[52:53], v9 offset:36864
    ds_read_b64_tr_b16 v[54:55], v9 offset:37888
    v_mfma_f32_16x16x32_bf16 v[24:27], v[88:91], v[124:127], v[24:27]
    ds_read_b64_tr_b16 v[56:57], v10 offset:36864
    ds_read_b64_tr_b16 v[58:59], v10 offset:37888
    v_mfma_f32_16x16x32_bf16 v[28:31], v[92:95], v[124:127], v[28:31]
    ds_read_b64_tr_b16 v[60:61], v11 offset:36864
    ds_read_b64_tr_b16 v[62:63], v11 offset:37888
    s_waitcnt vmcnt(14) lgkmcnt(0)
    s_barrier
    s_add_u32 m0, s47, 32768
    s_mov_b32 s44, 131072
    buffer_load_dwordx4 v12, s[28:31], s44 offen offset:0 lds
    v_mfma_f32_16x16x32_bf16 v[16:19], v[32:35], v[128:131], v[16:19]
    ds_read_b64_tr_b16 v[64:65], v8 offset:40960
    ds_read_b64_tr_b16 v[66:67], v8 offset:41984
    buffer_load_dwordx4 v13, s[28:31], s44 offen offset:1024 lds
    v_mfma_f32_16x16x32_bf16 v[20:23], v[36:39], v[128:131], v[20:23]
    ds_read_b64_tr_b16 v[68:69], v9 offset:40960
    ds_read_b64_tr_b16 v[70:71], v9 offset:41984
    v_mfma_f32_16x16x32_bf16 v[24:27], v[40:43], v[128:131], v[24:27]
    ds_read_b64_tr_b16 v[72:73], v10 offset:40960
    ds_read_b64_tr_b16 v[74:75], v10 offset:41984
    v_mfma_f32_16x16x32_bf16 v[28:31], v[44:47], v[128:131], v[28:31]
    ds_read_b64_tr_b16 v[76:77], v11 offset:40960
    ds_read_b64_tr_b16 v[78:79], v11 offset:41984
    v_mfma_f32_16x16x32_bf16 v[16:19], v[48:51], v[132:135], v[16:19]
    ds_read_b64_tr_b16 v[80:81], v8 offset:45056
    ds_read_b64_tr_b16 v[82:83], v8 offset:46080
    v_mfma_f32_16x16x32_bf16 v[20:23], v[52:55], v[132:135], v[20:23]
    ds_read_b64_tr_b16 v[84:85], v9 offset:45056
    ds_read_b64_tr_b16 v[86:87], v9 offset:46080
    v_mfma_f32_16x16x32_bf16 v[24:27], v[56:59], v[132:135], v[24:27]
    ds_read_b64_tr_b16 v[88:89], v10 offset:45056
    ds_read_b64_tr_b16 v[90:91], v10 offset:46080
    v_mfma_f32_16x16x32_bf16 v[28:31], v[60:63], v[132:135], v[28:31]
    ds_read_b64_tr_b16 v[92:93], v11 offset:45056
    ds_read_b64_tr_b16 v[94:95], v11 offset:46080
    s_waitcnt vmcnt(12) lgkmcnt(0)
    s_barrier
    s_add_u32 m0, s47, 40960
    s_mov_b32 s44, 196608
    buffer_load_dwordx4 v12, s[28:31], s44 offen offset:0 lds
    v_mfma_f32_16x16x32_bf16 v[16:19], v[64:67], v[136:139], v[16:19]
    ds_read_b64_tr_b16 v[32:33], v8 offset:0
    ds_read_b64_tr_b16 v[34:35], v8 offset:1024
    buffer_load_dwordx4 v13, s[28:31], s44 offen offset:1024 lds
    v_mfma_f32_16x16x32_bf16 v[20:23], v[68:71], v[136:139], v[20:23]
    ds_read_b64_tr_b16 v[36:37], v9 offset:0
    ds_read_b64_tr_b16 v[38:39], v9 offset:1024
    v_mfma_f32_16x16x32_bf16 v[24:27], v[72:75], v[136:139], v[24:27]
    ds_read_b64_tr_b16 v[40:41], v10 offset:0
    ds_read_b64_tr_b16 v[42:43], v10 offset:1024
    v_mfma_f32_16x16x32_bf16 v[28:31], v[76:79], v[136:139], v[28:31]
    ds_read_b64_tr_b16 v[44:45], v11 offset:0
    ds_read_b64_tr_b16 v[46:47], v11 offset:1024
    v_mfma_f32_16x16x32_bf16 v[16:19], v[80:83], v[140:143], v[16:19]
    ds_read_b64_tr_b16 v[48:49], v8 offset:4096
    ds_read_b64_tr_b16 v[50:51], v8 offset:5120
    v_mfma_f32_16x16x32_bf16 v[20:23], v[84:87], v[140:143], v[20:23]
    ds_read_b64_tr_b16 v[52:53], v9 offset:4096
    ds_read_b64_tr_b16 v[54:55], v9 offset:5120
    v_mfma_f32_16x16x32_bf16 v[24:27], v[88:91], v[140:143], v[24:27]
    ds_read_b64_tr_b16 v[56:57], v10 offset:4096
    ds_read_b64_tr_b16 v[58:59], v10 offset:5120
    v_mfma_f32_16x16x32_bf16 v[28:31], v[92:95], v[140:143], v[28:31]
    ds_read_b64_tr_b16 v[60:61], v11 offset:4096
    ds_read_b64_tr_b16 v[62:63], v11 offset:5120
    s_waitcnt vmcnt(10) lgkmcnt(0)
    s_barrier
    s_add_u32 m0, s47, 0
    s_mov_b32 s44, 262144
    buffer_load_dwordx4 v12, s[28:31], s44 offen offset:0 lds
    v_mfma_f32_16x16x32_bf16 v[16:19], v[32:35], v[96:99], v[16:19]
    ds_read_b64_tr_b16 v[64:65], v8 offset:8192
    ds_read_b64_tr_b16 v[66:67], v8 offset:9216
    buffer_load_dwordx4 v13, s[28:31], s44 offen offset:1024 lds
    v_mfma_f32_16x16x32_bf16 v[20:23], v[36:39], v[96:99], v[20:23]
    ds_read_b64_tr_b16 v[68:69], v9 offset:8192
    ds_read_b64_tr_b16 v[70:71], v9 offset:9216
    v_mfma_f32_16x16x32_bf16 v[24:27], v[40:43], v[96:99], v[24:27]
    ds_read_b64_tr_b16 v[72:73], v10 offset:8192
    ds_read_b64_tr_b16 v[74:75], v10 offset:9216
    v_mfma_f32_16x16x32_bf16 v[28:31], v[44:47], v[96:99], v[28:31]
    ds_read_b64_tr_b16 v[76:77], v11 offset:8192
    ds_read_b64_tr_b16 v[78:79], v11 offset:9216
    v_mfma_f32_16x16x32_bf16 v[16:19], v[48:51], v[100:103], v[16:19]
    ds_read_b64_tr_b16 v[80:81], v8 offset:12288
    ds_read_b64_tr_b16 v[82:83], v8 offset:13312
    v_mfma_f32_16x16x32_bf16 v[20:23], v[52:55], v[100:103], v[20:23]
    ds_read_b64_tr_b16 v[84:85], v9 offset:12288
    ds_read_b64_tr_b16 v[86:87], v9 offset:13312
    v_mfma_f32_16x16x32_bf16 v[24:27], v[56:59], v[100:103], v[24:27]
    ds_read_b64_tr_b16 v[88:89], v10 offset:12288
    ds_read_b64_tr_b16 v[90:91], v10 offset:13312
    v_mfma_f32_16x16x32_bf16 v[28:31], v[60:63], v[100:103], v[28:31]
    ds_read_b64_tr_b16 v[92:93], v11 offset:12288
    ds_read_b64_tr_b16 v[94:95], v11 offset:13312
    s_waitcnt vmcnt(8) lgkmcnt(0)
    s_barrier
    s_add_u32 m0, s47, 8192
    s_mov_b32 s44, 327680
    buffer_load_dwordx4 v12, s[28:31], s44 offen offset:0 lds
    v_mfma_f32_16x16x32_bf16 v[16:19], v[64:67], v[104:107], v[16:19]
    ds_read_b64_tr_b16 v[32:33], v8 offset:16384
    ds_read_b64_tr_b16 v[34:35], v8 offset:17408
    buffer_load_dwordx4 v13, s[28:31], s44 offen offset:1024 lds
    v_mfma_f32_16x16x32_bf16 v[20:23], v[68:71], v[104:107], v[20:23]
    ds_read_b64_tr_b16 v[36:37], v9 offset:16384
    ds_read_b64_tr_b16 v[38:39], v9 offset:17408
    v_mfma_f32_16x16x32_bf16 v[24:27], v[72:75], v[104:107], v[24:27]
    ds_read_b64_tr_b16 v[40:41], v10 offset:16384
    ds_read_b64_tr_b16 v[42:43], v10 offset:17408
    v_mfma_f32_16x16x32_bf16 v[28:31], v[76:79], v[104:107], v[28:31]
    ds_read_b64_tr_b16 v[44:45], v11 offset:16384
    ds_read_b64_tr_b16 v[46:47], v11 offset:17408
    v_mfma_f32_16x16x32_bf16 v[16:19], v[80:83], v[108:111], v[16:19]
    ds_read_b64_tr_b16 v[48:49], v8 offset:20480
    ds_read_b64_tr_b16 v[50:51], v8 offset:21504
    v_mfma_f32_16x16x32_bf16 v[20:23], v[84:87], v[108:111], v[20:23]
    ds_read_b64_tr_b16 v[52:53], v9 offset:20480
    ds_read_b64_tr_b16 v[54:55], v9 offset:21504
    v_mfma_f32_16x16x32_bf16 v[24:27], v[88:91], v[108:111], v[24:27]
    ds_read_b64_tr_b16 v[56:57], v10 offset:20480
    ds_read_b64_tr_b16 v[58:59], v10 offset:21504
    v_mfma_f32_16x16x32_bf16 v[28:31], v[92:95], v[108:111], v[28:31]
    ds_read_b64_tr_b16 v[60:61], v11 offset:20480
    ds_read_b64_tr_b16 v[62:63], v11 offset:21504
    s_cmp_eq_u32 s20, 0
    s_cbranch_scc0 K2_npg
    s_lshl_b32 s43, s18, 5
    s_add_u32 s43, s43, 21562368
    v_and_b32 v2, 7, v1
    v_lshlrev_b32 v2, 2, v2
    s_mov_b32 s49, 0
K2_plg:
    buffer_load_dword v3, v2, s[32:35], s43 offen sc1
    s_waitcnt vmcnt(0)
    v_cmp_eq_u32 vcc, 0, v3
    s_add_u32 s49, s49, 1
    s_cmp_ge_u32 s49, 0x40000
    s_cbranch_scc1 K2_npg
    s_cbranch_vccnz K2_plg
K2_npg:
    s_barrier
    s_add_u32 s43, s48, 16384
    buffer_load_dwordx4 v[112:115], v14, s[32:35], s43 offen offset:0 sc1
    buffer_load_dwordx4 v[116:119], v14, s[32:35], s43 offen offset:1024 sc1
    s_add_u32 s43, s48, 18432
    buffer_load_dwordx4 v[120:123], v14, s[32:35], s43 offen offset:0 sc1
    buffer_load_dwordx4 v[124:127], v14, s[32:35], s43 offen offset:1024 sc1
    s_add_u32 s43, s48, 20480
    buffer_load_dwordx4 v[128:131], v14, s[32:35], s43 offen offset:0 sc1
    buffer_load_dwordx4 v[132:135], v14, s[32:35], s43 offen offset:1024 sc1
    s_add_u32 s43, s48, 22528
    buffer_load_dwordx4 v[136:139], v14, s[32:35], s43 offen offset:0 sc1
    buffer_load_dwordx4 v[140:143], v14, s[32:35], s43 offen offset:1024 sc1
    s_add_u32 s43, s48, 24576
    buffer_load_dwordx4 v[96:99], v14, s[32:35], s43 offen offset:0 sc1
    buffer_load_dwordx4 v[100:103], v14, s[32:35], s43 offen offset:1024 sc1
    s_waitcnt vmcnt(8) lgkmcnt(0)
    s_barrier
    s_add_u32 m0, s47, 16384
    s_mov_b32 s44, 393216
    buffer_load_dwordx4 v12, s[28:31], s44 offen offset:0 lds
    v_mfma_f32_16x16x32_bf16 v[16:19], v[32:35], v[112:115], v[16:19]
    ds_read_b64_tr_b16 v[64:65], v8 offset:24576
    ds_read_b64_tr_b16 v[66:67], v8 offset:25600
    buffer_load_dwordx4 v13, s[28:31], s44 offen offset:1024 lds
    v_mfma_f32_16x16x32_bf16 v[20:23], v[36:39], v[112:115], v[20:23]
    ds_read_b64_tr_b16 v[68:69], v9 offset:24576
    ds_read_b64_tr_b16 v[70:71], v9 offset:25600
    s_add_u32 s43, s48, 26624
    buffer_load_dwordx4 v[104:107], v14, s[32:35], s43 offen offset:0 sc1
    v_mfma_f32_16x16x32_bf16 v[24:27], v[40:43], v[112:115], v[24:27]
    ds_read_b64_tr_b16 v[72:73], v10 offset:24576
    ds_read_b64_tr_b16 v[74:75], v10 offset:25600
    buffer_load_dwordx4 v[108:111], v14, s[32:35], s43 offen offset:1024 sc1
    v_mfma_f32_16x16x32_bf16 v[28:31], v[44:47], v[112:115], v[28:31]
    ds_read_b64_tr_b16 v[76:77], v11 offset:24576
    ds_read_b64_tr_b16 v[78:79], v11 offset:25600
    v_mfma_f32_16x16x32_bf16 v[16:19], v[48:51], v[116:119], v[16:19]
    ds_read_b64_tr_b16 v[80:81], v8 offset:28672
    ds_read_b64_tr_b16 v[82:83], v8 offset:29696
    v_mfma_f32_16x16x32_bf16 v[20:23], v[52:55], v[116:119], v[20:23]
    ds_read_b64_tr_b16 v[84:85], v9 offset:28672
    ds_read_b64_tr_b16 v[86:87], v9 offset:29696
    v_mfma_f32_16x16x32_bf16 v[24:27], v[56:59], v[116:119], v[24:27]
    ds_read_b64_tr_b16 v[88:89], v10 offset:28672
    ds_read_b64_tr_b16 v[90:91], v10 offset:29696
    v_mfma_f32_16x16x32_bf16 v[28:31], v[60:63], v[116:119], v[28:31]
    ds_read_b64_tr_b16 v[92:93], v11 offset:28672
    ds_read_b64_tr_b16 v[94:95], v11 offset:29696
    s_waitcnt vmcnt(10) lgkmcnt(0)
    s_barrier
    s_add_u32 m0, s47, 24576
    s_mov_b32 s44, 458752
    buffer_load_dwordx4 v12, s[28:31], s44 offen offset:0 lds
    v_mfma_f32_16x16x32_bf16 v[16:19], v[64:67], v[120:123], v[16:19]
    ds_read_b64_tr_b16 v[32:33], v8 offset:32768
    ds_read_b64_tr_b16 v[34:35], v8 offset:33792
    buffer_load_dwordx4 v13, s[28:31], s44 offen offset:1024 lds
    v_mfma_f32_16x16x32_bf16 v[20:23], v[68:71], v[120:123], v[20:23]
    ds_read_b64_tr_b16 v[36:37], v9 offset:32768
    ds_read_b64_tr_b16 v[38:39], v9 offset:33792
    s_add_u32 s43, s48, 28672
    buffer_load_dwordx4 v[112:115], v14, s[32:35], s43 offen offset:0 sc1
    v_mfma_f32_16x16x32_bf16 v[24:27], v[72:75], v[120:123], v[24:27]
    ds_read_b64_tr_b16 v[40:41], v10 offset:32768
    ds_read_b64_tr_b16 v[42:43], v10 offset:33792
    buffer_load_dwordx4 v[116:119], v14, s[32:35], s43 offen offset:1024 sc1
    v_mfma_f32_16x16x32_bf16 v[28:31], v[76:79], v[120:123], v[28:31]
    ds_read_b64_tr_b16 v[44:45], v11 offset:32768
    ds_read_b64_tr_b16 v[46:47], v11 offset:33792
    v_mfma_f32_16x16x32_bf16 v[16:19], v[80:83], v[124:127], v[16:19]
    ds_read_b64_tr_b16 v[48:49], v8 offset:36864
    ds_read_b64_tr_b16 v[50:51], v8 offset:37888
    v_mfma_f32_16x16x32_bf16 v[20:23], v[84:87], v[124:127], v[20:23]
    ds_read_b64_tr_b16 v[52:53], v9 offset:36864
    ds_read_b64_tr_b16 v[54:55], v9 offset:37888
    v_mfma_f32_16x16x32_bf16 v[24:27], v[88:91], v[124:127], v[24:27]
    ds_read_b64_tr_b16 v[56:57], v10 offset:36864
    ds_read_b64_tr_b16 v[58:59], v10 offset:37888
    v_mfma_f32_16x16x32_bf16 v[28:31], v[92:95], v[124:127], v[28:31]
    ds_read_b64_tr_b16 v[60:61], v11 offset:36864
    ds_read_b64_tr_b16 v[62:63], v11 offset:37888
    s_waitcnt vmcnt(12) lgkmcnt(0)
    s_barrier
    s_add_u32 m0, s47, 32768
    s_mov_b32 s44, 524288
    buffer_load_dwordx4 v12, s[28:31], s44 offen offset:0 lds
    v_mfma_f32_16x16x32_bf16 v[16:19], v[32:35], v[128:131], v[16:19]
    ds_read_b64_tr_b16 v[64:65], v8 offset:40960
    ds_read_b64_tr_b16 v[66:67], v8 offset:41984
    buffer_load_dwordx4 v13, s[28:31], s44 offen offset:1024 lds
    v_mfma_f32_16x16x32_bf16 v[20:23], v[36:39], v[128:131], v[20:23]
    ds_read_b64_tr_b16 v[68:69], v9 offset:40960
    ds_read_b64_tr_b16 v[70:71], v9 offset:41984
    s_add_u32 s43, s48, 30720
    buffer_load_dwordx4 v[120:123], v14, s[32:35], s43 offen offset:0 sc1
    v_mfma_f32_16x16x32_bf16 v[24:27], v[40:43], v[128:131], v[24:27]
    ds_read_b64_tr_b16 v[72:73], v10 offset:40960
    ds_read_b64_tr_b16 v[74:75], v10 offset:41984
    buffer_load_dwordx4 v[124:127], v14, s[32:35], s43 offen offset:1024 sc1
    v_mfma_f32_16x16x32_bf16 v[28:31], v[44:47], v[128:131], v[28:31]
    ds_read_b64_tr_b16 v[76:77], v11 offset:40960
    ds_read_b64_tr_b16 v[78:79], v11 offset:41984
    v_mfma_f32_16x16x32_bf16 v[16:19], v[48:51], v[132:135], v[16:19]
    ds_read_b64_tr_b16 v[80:81], v8 offset:45056
    ds_read_b64_tr_b16 v[82:83], v8 offset:46080
    v_mfma_f32_16x16x32_bf16 v[20:23], v[52:55], v[132:135], v[20:23]
    ds_read_b64_tr_b16 v[84:85], v9 offset:45056
    ds_read_b64_tr_b16 v[86:87], v9 offset:46080
    v_mfma_f32_16x16x32_bf16 v[24:27], v[56:59], v[132:135], v[24:27]
    ds_read_b64_tr_b16 v[88:89], v10 offset:45056
    ds_read_b64_tr_b16 v[90:91], v10 offset:46080
    v_mfma_f32_16x16x32_bf16 v[28:31], v[60:63], v[132:135], v[28:31]
    ds_read_b64_tr_b16 v[92:93], v11 offset:45056
    ds_read_b64_tr_b16 v[94:95], v11 offset:46080
    s_waitcnt vmcnt(14) lgkmcnt(0)
    s_barrier
    s_add_u32 m0, s47, 40960
    s_mov_b32 s44, 589824
    buffer_load_dwordx4 v12, s[28:31], s44 offen offset:0 lds
    v_mfma_f32_16x16x32_bf16 v[16:19], v[64:67], v[136:139], v[16:19]
    ds_read_b64_tr_b16 v[32:33], v8 offset:0
    ds_read_b64_tr_b16 v[34:35], v8 offset:1024
    buffer_load_dwordx4 v13, s[28:31], s44 offen offset:1024 lds
    v_mfma_f32_16x16x32_bf16 v[20:23], v[68:71], v[136:139], v[20:23]
    ds_read_b64_tr_b16 v[36:37], v9 offset:0
    ds_read_b64_tr_b16 v[38:39], v9 offset:1024
    s_add_u32 s43, s48, 32768
    buffer_load_dwordx4 v[128:131], v14, s[32:35], s43 offen offset:0 sc1
    v_mfma_f32_16x16x32_bf16 v[24:27], v[72:75], v[136:139], v[24:27]
    ds_read_b64_tr_b16 v[40:41], v10 offset:0
    ds_read_b64_tr_b16 v[42:43], v10 offset:1024
    buffer_load_dwordx4 v[132:135], v14, s[32:35], s43 offen offset:1024 sc1
    v_mfma_f32_16x16x32_bf16 v[28:31], v[76:79], v[136:139], v[28:31]
    ds_read_b64_tr_b16 v[44:45], v11 offset:0
    ds_read_b64_tr_b16 v[46:47], v11 offset:1024
    v_mfma_f32_16x16x32_bf16 v[16:19], v[80:83], v[140:143], v[16:19]
    ds_read_b64_tr_b16 v[48:49], v8 offset:4096
    ds_read_b64_tr_b16 v[50:51], v8 offset:5120
    v_mfma_f32_16x16x32_bf16 v[20:23], v[84:87], v[140:143], v[20:23]
    ds_read_b64_tr_b16 v[52:53], v9 offset:4096
    ds_read_b64_tr_b16 v[54:55], v9 offset:5120
    v_mfma_f32_16x16x32_bf16 v[24:27], v[88:91], v[140:143], v[24:27]
    ds_read_b64_tr_b16 v[56:57], v10 offset:4096
    ds_read_b64_tr_b16 v[58:59], v10 offset:5120
    v_mfma_f32_16x16x32_bf16 v[28:31], v[92:95], v[140:143], v[28:31]
    ds_read_b64_tr_b16 v[60:61], v11 offset:4096
    ds_read_b64_tr_b16 v[62:63], v11 offset:5120
    s_waitcnt vmcnt(16) lgkmcnt(0)
    s_barrier
    s_add_u32 m0, s47, 0
    s_mov_b32 s44, 655360
    buffer_load_dwordx4 v12, s[28:31], s44 offen offset:0 lds
    v_mfma_f32_16x16x32_bf16 v[16:19], v[32:35], v[96:99], v[16:19]
    ds_read_b64_tr_b16 v[64:65], v8 offset:8192
    ds_read_b64_tr_b16 v[66:67], v8 offset:9216
    buffer_load_dwordx4 v13, s[28:31], s44 offen offset:1024 lds
    v_mfma_f32_16x16x32_bf16 v[20:23], v[36:39], v[96:99], v[20:23]
    ds_read_b64_tr_b16 v[68:69], v9 offset:8192
    ds_read_b64_tr_b16 v[70:71], v9 offset:9216
    s_add_u32 s43, s48, 34816
    buffer_load_dwordx4 v[136:139], v14, s[32:35], s43 offen offset:0 sc1
    v_mfma_f32_16x16x32_bf16 v[24:27], v[40:43], v[96:99], v[24:27]
    ds_read_b64_tr_b16 v[72:73], v10 offset:8192
    ds_read_b64_tr_b16 v[74:75], v10 offset:9216
    buffer_load_dwordx4 v[140:143], v14, s[32:35], s43 offen offset:1024 sc1
    v_mfma_f32_16x16x32_bf16 v[28:31], v[44:47], v[96:99], v[28:31]
    ds_read_b64_tr_b16 v[76:77], v11 offset:8192
    ds_read_b64_tr_b16 v[78:79], v11 offset:9216
    v_mfma_f32_16x16x32_bf16 v[16:19], v[48:51], v[100:103], v[16:19]
    ds_read_b64_tr_b16 v[80:81], v8 offset:12288
    ds_read_b64_tr_b16 v[82:83], v8 offset:13312
    v_mfma_f32_16x16x32_bf16 v[20:23], v[52:55], v[100:103], v[20:23]
    ds_read_b64_tr_b16 v[84:85], v9 offset:12288
    ds_read_b64_tr_b16 v[86:87], v9 offset:13312
    v_mfma_f32_16x16x32_bf16 v[24:27], v[56:59], v[100:103], v[24:27]
    ds_read_b64_tr_b16 v[88:89], v10 offset:12288
    ds_read_b64_tr_b16 v[90:91], v10 offset:13312
    v_mfma_f32_16x16x32_bf16 v[28:31], v[60:63], v[100:103], v[28:31]
    ds_read_b64_tr_b16 v[92:93], v11 offset:12288
    ds_read_b64_tr_b16 v[94:95], v11 offset:13312
    s_waitcnt vmcnt(16) lgkmcnt(0)
    s_barrier
    s_add_u32 m0, s47, 8192
    s_mov_b32 s44, 720896
    buffer_load_dwordx4 v12, s[28:31], s44 offen offset:0 lds
    v_mfma_f32_16x16x32_bf16 v[16:19], v[64:67], v[104:107], v[16:19]
    ds_read_b64_tr_b16 v[32:33], v8 offset:16384
    ds_read_b64_tr_b16 v[34:35], v8 offset:17408
    buffer_load_dwordx4 v13, s[28:31], s44 offen offset:1024 lds
    v_mfma_f32_16x16x32_bf16 v[20:23], v[68:71], v[104:107], v[20:23]
    ds_read_b64_tr_b16 v[36:37], v9 offset:16384
    ds_read_b64_tr_b16 v[38:39], v9 offset:17408
    s_add_u32 s43, s48, 36864
    buffer_load_dwordx4 v[96:99], v14, s[32:35], s43 offen offset:0 sc1
    v_mfma_f32_16x16x32_bf16 v[24:27], v[72:75], v[104:107], v[24:27]
    ds_read_b64_tr_b16 v[40:41], v10 offset:16384
    ds_read_b64_tr_b16 v[42:43], v10 offset:17408
    buffer_load_dwordx4 v[100:103], v14, s[32:35], s43 offen offset:1024 sc1
    v_mfma_f32_16x16x32_bf16 v[28:31], v[76:79], v[104:107], v[28:31]
    ds_read_b64_tr_b16 v[44:45], v11 offset:16384
    ds_read_b64_tr_b16 v[46:47], v11 offset:17408
    v_mfma_f32_16x16x32_bf16 v[16:19], v[80:83], v[108:111], v[16:19]
    ds_read_b64_tr_b16 v[48:49], v8 offset:20480
    ds_read_b64_tr_b16 v[50:51], v8 offset:21504
    v_mfma_f32_16x16x32_bf16 v[20:23], v[84:87], v[108:111], v[20:23]
    ds_read_b64_tr_b16 v[52:53], v9 offset:20480
    ds_read_b64_tr_b16 v[54:55], v9 offset:21504
    v_mfma_f32_16x16x32_bf16 v[24:27], v[88:91], v[108:111], v[24:27]
    ds_read_b64_tr_b16 v[56:57], v10 offset:20480
    ds_read_b64_tr_b16 v[58:59], v10 offset:21504
    v_mfma_f32_16x16x32_bf16 v[28:31], v[92:95], v[108:111], v[28:31]
    ds_read_b64_tr_b16 v[60:61], v11 offset:20480
    ds_read_b64_tr_b16 v[62:63], v11 offset:21504
    s_waitcnt vmcnt(16) lgkmcnt(0)
    s_barrier
    s_add_u32 m0, s47, 16384
    s_mov_b32 s44, 786432
    buffer_load_dwordx4 v12, s[28:31], s44 offen offset:0 lds
    v_mfma_f32_16x16x32_bf16 v[16:19], v[32:35], v[112:115], v[16:19]
    ds_read_b64_tr_b16 v[64:65], v8 offset:24576
    ds_read_b64_tr_b16 v[66:67], v8 offset:25600
    buffer_load_dwordx4 v13, s[28:31], s44 offen offset:1024 lds
    v_mfma_f32_16x16x32_bf16 v[20:23], v[36:39], v[112:115], v[20:23]
    ds_read_b64_tr_b16 v[68:69], v9 offset:24576
    ds_read_b64_tr_b16 v[70:71], v9 offset:25600
    s_add_u32 s43, s48, 38912
    buffer_load_dwordx4 v[104:107], v14, s[32:35], s43 offen offset:0 sc1
    v_mfma_f32_16x16x32_bf16 v[24:27], v[40:43], v[112:115], v[24:27]
    ds_read_b64_tr_b16 v[72:73], v10 offset:24576
    ds_read_b64_tr_b16 v[74:75], v10 offset:25600
    buffer_load_dwordx4 v[108:111], v14, s[32:35], s43 offen offset:1024 sc1
    v_mfma_f32_16x16x32_bf16 v[28:31], v[44:47], v[112:115], v[28:31]
    ds_read_b64_tr_b16 v[76:77], v11 offset:24576
    ds_read_b64_tr_b16 v[78:79], v11 offset:25600
    v_mfma_f32_16x16x32_bf16 v[16:19], v[48:51], v[116:119], v[16:19]
    ds_read_b64_tr_b16 v[80:81], v8 offset:28672
    ds_read_b64_tr_b16 v[82:83], v8 offset:29696
    v_mfma_f32_16x16x32_bf16 v[20:23], v[52:55], v[116:119], v[20:23]
    ds_read_b64_tr_b16 v[84:85], v9 offset:28672
    ds_read_b64_tr_b16 v[86:87], v9 offset:29696
    v_mfma_f32_16x16x32_bf16 v[24:27], v[56:59], v[116:119], v[24:27]
    ds_read_b64_tr_b16 v[88:89], v10 offset:28672
    ds_read_b64_tr_b16 v[90:91], v10 offset:29696
    v_mfma_f32_16x16x32_bf16 v[28:31], v[60:63], v[116:119], v[28:31]
    ds_read_b64_tr_b16 v[92:93], v11 offset:28672
    ds_read_b64_tr_b16 v[94:95], v11 offset:29696
    s_waitcnt vmcnt(16) lgkmcnt(0)
    s_barrier
    s_add_u32 m0, s47, 24576
    s_mov_b32 s44, 851968
    buffer_load_dwordx4 v12, s[28:31], s44 offen offset:0 lds
    v_mfma_f32_16x16x32_bf16 v[16:19], v[64:67], v[120:123], v[16:19]
    ds_read_b64_tr_b16 v[32:33], v8 offset:32768
    ds_read_b64_tr_b16 v[34:35], v8 offset:33792
    buffer_load_dwordx4 v13, s[28:31], s44 offen offset:1024 lds
    v_mfma_f32_16x16x32_bf16 v[20:23], v[68:71], v[120:123], v[20:23]
    ds_read_b64_tr_b16 v[36:37], v9 offset:32768
    ds_read_b64_tr_b16 v[38:39], v9 offset:33792
    s_add_u32 s43, s48, 40960
    buffer_load_dwordx4 v[112:115], v14, s[32:35], s43 offen offset:0 sc1
    v_mfma_f32_16x16x32_bf16 v[24:27], v[72:75], v[120:123], v[24:27]
    ds_read_b64_tr_b16 v[40:41], v10 offset:32768
    ds_read_b64_tr_b16 v[42:43], v10 offset:33792
    buffer_load_dwordx4 v[116:119], v14, s[32:35], s43 offen offset:1024 sc1
    v_mfma_f32_16x16x32_bf16 v[28:31], v[76:79], v[120:123], v[28:31]
    ds_read_b64_tr_b16 v[44:45], v11 offset:32768
    ds_read_b64_tr_b16 v[46:47], v11 offset:33792
    v_mfma_f32_16x16x32_bf16 v[16:19], v[80:83], v[124:127], v[16:19]
    ds_read_b64_tr_b16 v[48:49], v8 offset:36864
    ds_read_b64_tr_b16 v[50:51], v8 offset:37888
    v_mfma_f32_16x16x32_bf16 v[20:23], v[84:87], v[124:127], v[20:23]
    ds_read_b64_tr_b16 v[52:53], v9 offset:36864
    ds_read_b64_tr_b16 v[54:55], v9 offset:37888
    v_mfma_f32_16x16x32_bf16 v[24:27], v[88:91], v[124:127], v[24:27]
    ds_read_b64_tr_b16 v[56:57], v10 offset:36864
    ds_read_b64_tr_b16 v[58:59], v10 offset:37888
    v_mfma_f32_16x16x32_bf16 v[28:31], v[92:95], v[124:127], v[28:31]
    ds_read_b64_tr_b16 v[60:61], v11 offset:36864
    ds_read_b64_tr_b16 v[62:63], v11 offset:37888
    s_waitcnt vmcnt(16) lgkmcnt(0)
    s_barrier
    s_add_u32 s43, s48, 43008
    buffer_load_dwordx4 v[120:123], v14, s[32:35], s43 offen offset:0 sc1
    v_mfma_f32_16x16x32_bf16 v[16:19], v[32:35], v[128:131], v[16:19]
    ds_read_b64_tr_b16 v[64:65], v8 offset:40960
    ds_read_b64_tr_b16 v[66:67], v8 offset:41984
    buffer_load_dwordx4 v[124:127], v14, s[32:35], s43 offen offset:1024 sc1
    v_mfma_f32_16x16x32_bf16 v[20:23], v[36:39], v[128:131], v[20:23]
    ds_read_b64_tr_b16 v[68:69], v9 offset:40960
    ds_read_b64_tr_b16 v[70:71], v9 offset:41984
    v_mfma_f32_16x16x32_bf16 v[24:27], v[40:43], v[128:131], v[24:27]
    ds_read_b64_tr_b16 v[72:73], v10 offset:40960
    ds_read_b64_tr_b16 v[74:75], v10 offset:41984
    v_mfma_f32_16x16x32_bf16 v[28:31], v[44:47], v[128:131], v[28:31]
    ds_read_b64_tr_b16 v[76:77], v11 offset:40960
    ds_read_b64_tr_b16 v[78:79], v11 offset:41984
    v_mfma_f32_16x16x32_bf16 v[16:19], v[48:51], v[132:135], v[16:19]
    ds_read_b64_tr_b16 v[80:81], v8 offset:45056
    ds_read_b64_tr_b16 v[82:83], v8 offset:46080
    v_mfma_f32_16x16x32_bf16 v[20:23], v[52:55], v[132:135], v[20:23]
    ds_read_b64_tr_b16 v[84:85], v9 offset:45056
    ds_read_b64_tr_b16 v[86:87], v9 offset:46080
    v_mfma_f32_16x16x32_bf16 v[24:27], v[56:59], v[132:135], v[24:27]
    ds_read_b64_tr_b16 v[88:89], v10 offset:45056
    ds_read_b64_tr_b16 v[90:91], v10 offset:46080
    v_mfma_f32_16x16x32_bf16 v[28:31], v[60:63], v[132:135], v[28:31]
    ds_read_b64_tr_b16 v[92:93], v11 offset:45056
    ds_read_b64_tr_b16 v[94:95], v11 offset:46080
    s_waitcnt vmcnt(14) lgkmcnt(0)
    s_barrier
    v_mfma_f32_16x16x32_bf16 v[16:19], v[64:67], v[136:139], v[16:19]
    ds_read_b64_tr_b16 v[32:33], v8 offset:0
    ds_read_b64_tr_b16 v[34:35], v8 offset:1024
    v_mfma_f32_16x16x32_bf16 v[20:23], v[68:71], v[136:139], v[20:23]
    ds_read_b64_tr_b16 v[36:37], v9 offset:0
    ds_read_b64_tr_b16 v[38:39], v9 offset:1024
    v_mfma_f32_16x16x32_bf16 v[24:27], v[72:75], v[136:139], v[24:27]
    ds_read_b64_tr_b16 v[40:41], v10 offset:0
    ds_read_b64_tr_b16 v[42:43], v10 offset:1024
    v_mfma_f32_16x16x32_bf16 v[28:31], v[76:79], v[136:139], v[28:31]
    ds_read_b64_tr_b16 v[44:45], v11 offset:0
    ds_read_b64_tr_b16 v[46:47], v11 offset:1024
    v_mfma_f32_16x16x32_bf16 v[16:19], v[80:83], v[140:143], v[16:19]
    ds_read_b64_tr_b16 v[48:49], v8 offset:4096
    ds_read_b64_tr_b16 v[50:51], v8 offset:5120
    v_mfma_f32_16x16x32_bf16 v[20:23], v[84:87], v[140:143], v[20:23]
    ds_read_b64_tr_b16 v[52:53], v9 offset:4096
    ds_read_b64_tr_b16 v[54:55], v9 offset:5120
    v_mfma_f32_16x16x32_bf16 v[24:27], v[88:91], v[140:143], v[24:27]
    ds_read_b64_tr_b16 v[56:57], v10 offset:4096
    ds_read_b64_tr_b16 v[58:59], v10 offset:5120
    v_mfma_f32_16x16x32_bf16 v[28:31], v[92:95], v[140:143], v[28:31]
    ds_read_b64_tr_b16 v[60:61], v11 offset:4096
    ds_read_b64_tr_b16 v[62:63], v11 offset:5120
    s_waitcnt vmcnt(10) lgkmcnt(0)
    s_barrier
    v_mfma_f32_16x16x32_bf16 v[16:19], v[32:35], v[96:99], v[16:19]
    ds_read_b64_tr_b16 v[64:65], v8 offset:8192
    ds_read_b64_tr_b16 v[66:67], v8 offset:9216
    v_mfma_f32_16x16x32_bf16 v[20:23], v[36:39], v[96:99], v[20:23]
    ds_read_b64_tr_b16 v[68:69], v9 offset:8192
    ds_read_b64_tr_b16 v[70:71], v9 offset:9216
    v_mfma_f32_16x16x32_bf16 v[24:27], v[40:43], v[96:99], v[24:27]
    ds_read_b64_tr_b16 v[72:73], v10 offset:8192
    ds_read_b64_tr_b16 v[74:75], v10 offset:9216
    v_mfma_f32_16x16x32_bf16 v[28:31], v[44:47], v[96:99], v[28:31]
    ds_read_b64_tr_b16 v[76:77], v11 offset:8192
    ds_read_b64_tr_b16 v[78:79], v11 offset:9216
    v_mfma_f32_16x16x32_bf16 v[16:19], v[48:51], v[100:103], v[16:19]
    ds_read_b64_tr_b16 v[80:81], v8 offset:12288
    ds_read_b64_tr_b16 v[82:83], v8 offset:13312
    v_mfma_f32_16x16x32_bf16 v[20:23], v[52:55], v[100:103], v[20:23]
    ds_read_b64_tr_b16 v[84:85], v9 offset:12288
    ds_read_b64_tr_b16 v[86:87], v9 offset:13312
    v_mfma_f32_16x16x32_bf16 v[24:27], v[56:59], v[100:103], v[24:27]
    ds_read_b64_tr_b16 v[88:89], v10 offset:12288
    ds_read_b64_tr_b16 v[90:91], v10 offset:13312
    v_mfma_f32_16x16x32_bf16 v[28:31], v[60:63], v[100:103], v[28:31]
    ds_read_b64_tr_b16 v[92:93], v11 offset:12288
    ds_read_b64_tr_b16 v[94:95], v11 offset:13312
    s_waitcnt vmcnt(6) lgkmcnt(0)
    s_barrier
    v_mfma_f32_16x16x32_bf16 v[16:19], v[64:67], v[104:107], v[16:19]
    ds_read_b64_tr_b16 v[32:33], v8 offset:16384
    ds_read_b64_tr_b16 v[34:35], v8 offset:17408
    v_mfma_f32_16x16x32_bf16 v[20:23], v[68:71], v[104:107], v[20:23]
    ds_read_b64_tr_b16 v[36:37], v9 offset:16384
    ds_read_b64_tr_b16 v[38:39], v9 offset:17408
    v_mfma_f32_16x16x32_bf16 v[24:27], v[72:75], v[104:107], v[24:27]
    ds_read_b64_tr_b16 v[40:41], v10 offset:16384
    ds_read_b64_tr_b16 v[42:43], v10 offset:17408
    v_mfma_f32_16x16x32_bf16 v[28:31], v[76:79], v[104:107], v[28:31]
    ds_read_b64_tr_b16 v[44:45], v11 offset:16384
    ds_read_b64_tr_b16 v[46:47], v11 offset:17408
    v_mfma_f32_16x16x32_bf16 v[16:19], v[80:83], v[108:111], v[16:19]
    ds_read_b64_tr_b16 v[48:49], v8 offset:20480
    ds_read_b64_tr_b16 v[50:51], v8 offset:21504
    v_mfma_f32_16x16x32_bf16 v[20:23], v[84:87], v[108:111], v[20:23]
    ds_read_b64_tr_b16 v[52:53], v9 offset:20480
    ds_read_b64_tr_b16 v[54:55], v9 offset:21504
    v_mfma_f32_16x16x32_bf16 v[24:27], v[88:91], v[108:111], v[24:27]
    ds_read_b64_tr_b16 v[56:57], v10 offset:20480
    ds_read_b64_tr_b16 v[58:59], v10 offset:21504
    v_mfma_f32_16x16x32_bf16 v[28:31], v[92:95], v[108:111], v[28:31]
    ds_read_b64_tr_b16 v[60:61], v11 offset:20480
    ds_read_b64_tr_b16 v[62:63], v11 offset:21504
    s_waitcnt vmcnt(2) lgkmcnt(0)
    s_barrier
    v_mfma_f32_16x16x32_bf16 v[16:19], v[32:35], v[112:115], v[16:19]
    ds_read_b64_tr_b16 v[64:65], v8 offset:24576
    ds_read_b64_tr_b16 v[66:67], v8 offset:25600
    v_mfma_f32_16x16x32_bf16 v[20:23], v[36:39], v[112:115], v[20:23]
    ds_read_b64_tr_b16 v[68:69], v9 offset:24576
    ds_read_b64_tr_b16 v[70:71], v9 offset:25600
    v_mfma_f32_16x16x32_bf16 v[24:27], v[40:43], v[112:115], v[24:27]
    ds_read_b64_tr_b16 v[72:73], v10 offset:24576
    ds_read_b64_tr_b16 v[74:75], v10 offset:25600
    v_mfma_f32_16x16x32_bf16 v[28:31], v[44:47], v[112:115], v[28:31]
    ds_read_b64_tr_b16 v[76:77], v11 offset:24576
    ds_read_b64_tr_b16 v[78:79], v11 offset:25600
    v_mfma_f32_16x16x32_bf16 v[16:19], v[48:51], v[116:119], v[16:19]
    ds_read_b64_tr_b16 v[80:81], v8 offset:28672
    ds_read_b64_tr_b16 v[82:83], v8 offset:29696
    v_mfma_f32_16x16x32_bf16 v[20:23], v[52:55], v[116:119], v[20:23]
    ds_read_b64_tr_b16 v[84:85], v9 offset:28672
    ds_read_b64_tr_b16 v[86:87], v9 offset:29696
    v_mfma_f32_16x16x32_bf16 v[24:27], v[56:59], v[116:119], v[24:27]
    ds_read_b64_tr_b16 v[88:89], v10 offset:28672
    ds_read_b64_tr_b16 v[90:91], v10 offset:29696
    v_mfma_f32_16x16x32_bf16 v[28:31], v[60:63], v[116:119], v[28:31]
    ds_read_b64_tr_b16 v[92:93], v11 offset:28672
    ds_read_b64_tr_b16 v[94:95], v11 offset:29696
    s_waitcnt vmcnt(0) lgkmcnt(0)
    s_barrier
    v_mfma_f32_16x16x32_bf16 v[16:19], v[64:67], v[120:123], v[16:19]
    v_mfma_f32_16x16x32_bf16 v[20:23], v[68:71], v[120:123], v[20:23]
    v_mfma_f32_16x16x32_bf16 v[24:27], v[72:75], v[120:123], v[24:27]
    v_mfma_f32_16x16x32_bf16 v[28:31], v[76:79], v[120:123], v[28:31]
    v_mfma_f32_16x16x32_bf16 v[16:19], v[80:83], v[124:127], v[16:19]
    v_mfma_f32_16x16x32_bf16 v[20:23], v[84:87], v[124:127], v[20:23]
    v_mfma_f32_16x16x32_bf16 v[24:27], v[88:91], v[124:127], v[24:27]
    v_mfma_f32_16x16x32_bf16 v[28:31], v[92:95], v[124:127], v[28:31]
    v_and_b32 v2, 15, v1
    v_lshrrev_b32 v3, 4, v1
    s_lshl_b32 s43, s18, 2
    s_add_u32 s43, s43, s20
    s_lshl_b32 s43, s43, 4
    v_add_u32 v2, s43, v2
    v_lshlrev_b32 v2, 10, v2
    v_lshl_add_u32 v2, v3, 3, v2
    s_lshl_b32 s43, s19, 7
    v_cvt_pk_bf16_f32 v16, v16, v17
    v_cvt_pk_bf16_f32 v17, v18, v19
    buffer_store_dwordx2 v[16:17], v2, s[36:39], s43 offen offset:0
    v_cvt_pk_bf16_f32 v20, v20, v21
    v_cvt_pk_bf16_f32 v21, v22, v23
    buffer_store_dwordx2 v[20:21], v2, s[36:39], s43 offen offset:32
    v_cvt_pk_bf16_f32 v24, v24, v25
    v_cvt_pk_bf16_f32 v25, v26, v27
    buffer_store_dwordx2 v[24:25], v2, s[36:39], s43 offen offset:64
    v_cvt_pk_bf16_f32 v28, v28, v29
    v_cvt_pk_bf16_f32 v29, v30, v31
    buffer_store_dwordx2 v[28:29], v2, s[36:39], s43 offen offset:96
K2_fin:
K2_end:
    s_endpgm
gm_code_end:
    s_endpgm
.section .rodata,"a"
.p2align 6
.amdhsa_kernel gm_k1_kernel
  .amdhsa_next_free_vgpr 256
  .amdhsa_next_free_sgpr 102
  .amdhsa_accum_offset 256
  .amdhsa_group_segment_fixed_size 0
  .amdhsa_kernarg_size 96
  .amdhsa_user_sgpr_count 2
  .amdhsa_user_sgpr_kernarg_segment_ptr 1
  .amdhsa_system_sgpr_workgroup_id_x 1
  .amdhsa_float_denorm_mode_32 3
.end_amdhsa_kernel
.p2align 6
.amdhsa_kernel gm_k2_kernel
  .amdhsa_next_free_vgpr 256
  .amdhsa_next_free_sgpr 102
  .amdhsa_accum_offset 256
  .amdhsa_group_segment_fixed_size 0
  .amdhsa_kernarg_size 96
  .amdhsa_user_sgpr_count 2
  .amdhsa_user_sgpr_kernarg_segment_ptr 1
  .amdhsa_system_sgpr_workgroup_id_x 1
  .amdhsa_float_denorm_mode_32 3
.end_amdhsa_kernel
```
